```python
import torch

def _softmax(x, axis=-1):
    return torch.softmax(x, dim=axis)
def _gelu(x):
    return torch.nn.functional.gelu(x, approximate="tanh")
def _silu(x):
    return torch.nn.functional.silu(x)
def _sigmoid(x):
    return torch.sigmoid(x)
def _layernorm(x, axis=-1, eps=1e-5):
    m = x.mean(dim=axis, keepdim=True)
    v = x.var(dim=axis, keepdim=True, unbiased=False)
    return (x - m) / torch.sqrt(v + eps)
def _scatter_add(tgt, idx, src, axis=0):
    return tgt.clone().index_add_(axis, idx, src)
def _segment_sum(src, seg, n):
    out = torch.zeros((n,) + src.shape[1:], dtype=src.dtype)
    return out.index_add_(0, seg, src)
def _pad(x, pw):
    flat = tuple(v for pair in reversed(pw) for v in pair)
    return torch.nn.functional.pad(x, flat)

kernel_name = 'sequential_preLN__mha_block_cached__geglu_ffn__decode'

def setup_inputs():

    _w = (lambda a: (lambda t: t.to(torch.bfloat16) if t.is_floating_point() else t)(torch.as_tensor(a)))
    def _A_setup():
        B, Sq, D = 2, 1, 448
        H, Sk, Dh = 16, 8192, 256
        return {
            "x": _w((lambda *s: torch.randn(*s, dtype=torch.bfloat16) * 0.05)(B, Sq, D)),
            "k_cache": _w((lambda *s: torch.randn(*s, dtype=torch.bfloat16) * 3.2)(B, H, Sk, Dh)),
            "v_cache": _w((lambda *s: torch.randn(*s, dtype=torch.bfloat16) * 0.4)(B, H, Sk, Dh)),
            "wq": _w((lambda *s: torch.randn(*s, dtype=torch.bfloat16) * 3.2)(D, H * Dh) * (D ** -0.5)),
            "wo": _w((lambda *s: torch.randn(*s, dtype=torch.bfloat16) * 0.4)(H * Dh, D) * ((H * Dh) ** -0.5)),
        }
    _A_in = _A_setup()

    def _B_setup():
        B, S, D, F = 2, 1, 448, 1792
        return {
            "x": _w((lambda *s: torch.randn(*s, dtype=torch.bfloat16) * 0.05)(B, S, D)),
            "w_gate": _w((lambda *s: torch.randn(*s, dtype=torch.bfloat16) * 0.05)(D, F)),
            "w_up": _w((lambda *s: torch.randn(*s, dtype=torch.bfloat16) * 0.05)(D, F)),
            "w_down": _w((lambda *s: torch.randn(*s, dtype=torch.bfloat16) * 0.05)(F, D)),
        }
    _B_in = _B_setup()

    return {
        "A_x": _A_in["x"],
        "A_k_cache": _A_in["k_cache"],
        "A_v_cache": _A_in["v_cache"],
        "A_wq": _A_in["wq"],
        "A_wo": _A_in["wo"],
        "B_x": _B_in["x"],
        "B_w_gate": _B_in["w_gate"],
        "B_w_up": _B_in["w_up"],
        "B_w_down": _B_in["w_down"],
    }

def reference(A_x, A_k_cache, A_v_cache, A_wq, A_wo, B_x, B_w_gate, B_w_up, B_w_down):
    def _A_ref(x, k_cache, v_cache, wq, wo):
        B, Sq, D = x.shape
        H, Dh = 16, 256
        q = (lambda x, *d: x.permute(*d))((x @ wq).reshape(B, Sq, H, Dh), 0, 2, 1, 3)
        scores = torch.einsum("bhqd,bhkd->bhqk", q, k_cache) * (Dh ** -0.5)
        p = _softmax(scores, axis=-1)
        o = torch.einsum("bhqk,bhkd->bhqd", p, v_cache)
        return (lambda x, *d: x.permute(*d))(o, 0, 2, 1, 3).reshape(B, Sq, H * Dh) @ wo

    def _B_ref(x, w_gate, w_up, w_down):
        return (_gelu(x @ w_gate) * (x @ w_up)) @ w_down

    x = A_x
    h = x + _A_ref(_layernorm(x, axis=-1), A_k_cache, A_v_cache, A_wq, A_wo)
    h2 = h + _B_ref(_layernorm(h, axis=-1), B_w_gate, B_w_up, B_w_down)
    return h2
```

```asm
; @launch grid=(256,1,1) block=(384,1,1) lds=154240
.amdgcn_target "amdgcn-amd-amdhsa--gfx950"
.text
.globl sequential_preLN__mha_block_cached__geglu_ffn__decode_kernel
.p2align 8
.type sequential_preLN__mha_block_cached__geglu_ffn__decode_kernel,@function
sequential_preLN__mha_block_cached__geglu_ffn__decode_kernel:
    s_cmp_ge_u32 s2, 256
    s_cbranch_scc1 L_end
    s_load_dwordx16 s[4:19], s[0:1], 0
    s_load_dwordx8 s[20:27], s[0:1], 64
    v_lshrrev_b32 v2, 6, v0
    v_and_b32 v0, 63, v0
    v_readfirstlane_b32 s3, v2
    v_mov_b32 v1, 147456
    s_cmp_eq_u32 s3, 5
    s_cbranch_scc1 P_3
    s_cmp_eq_u32 s3, 3
    s_cbranch_scc1 P_0
    s_cmp_eq_u32 s3, 4
    s_cbranch_scc1 P_1
    s_cmp_eq_u32 s3, 1
    s_cbranch_scc1 P_2
    s_cmp_eq_u32 s3, 0
    s_cbranch_scc1 L_loader
    v_cmp_gt_u32 s[56:57], 56, v0
    v_mov_b32 v4, 0
    v_mov_b32 v5, -1
    v_mov_b32 v6, 32
    v_mov_b32 v7, 32
    v_mov_b32 v8, -2
    ds_write_b128 v1, v[4:7] offset:16
    ds_write_b32 v1, v8
    ds_write_b64 v1, v[4:5] offset:32
    ds_write_b64 v1, v[4:5] offset:40
    v_lshlrev_b32 v9, 4, v0
    v_mov_b32 v10, 2146435072
    v_cndmask_b32 v9, v10, v9, s[56:57]
    s_mov_b32 s42, 1792
    s_mov_b32 s43, 0x20000
    s_waitcnt lgkmcnt(0)
    s_mov_b32 s40, s4
    s_and_b32 s41, s5, 0xffff
    buffer_load_dwordx4 v[12:15], v9, s[40:43], 0 offen offset:896
    buffer_load_dwordx4 v[8:11], v9, s[40:43], 0 offen
    s_barrier
    s_branch L_qprod
L_loader:
    s_setprio 3
    v_lshrrev_b32 v17, 3, v0
    v_and_b32 v18, 6, v17
    v_and_b32 v19, 7, v0
    v_xor_b32 v18, v18, v19
    v_lshlrev_b32 v17, 13, v17
    v_lshl_add_u32 v17, v18, 4, v17
    s_bfe_u32 s50, s2, 0x20001
    s_mul_i32 s52, s50, 917504
    s_lshr_b32 s51, s2, 3
    s_lshl_b32 s51, s51, 7
    s_add_u32 s52, s52, s51
    s_and_b32 s53, s2, 1
    s_lshl_b32 s53, s53, 12
    s_add_u32 s52, s52, s53
    s_mov_b32 m0, 131072
    s_mov_b32 s42, 3670016
    s_mov_b32 s43, 0x20000
    s_mov_b32 s50, 13
    s_waitcnt lgkmcnt(0)
    s_mov_b32 s40, s10
    s_and_b32 s41, s11, 0xffff
L_wq:
    buffer_load_dwordx4 v17, s[40:43], s52 offen nt lds
    s_add_u32 s52, s52, 65536
    s_add_u32 m0, m0, 1024
    s_sub_u32 s50, s50, 1
    s_cbranch_scc0 L_wq
    v_lshrrev_b32 v2, 5, v0
    v_and_b32 v3, 31, v0
    v_lshlrev_b32 v30, 9, v2
    v_xor_b32 v28, v2, v3
    v_lshl_or_b32 v8, v28, 4, v30
    v_xor_b32 v9, 32, v8
    v_xor_b32 v10, 64, v8
    v_xor_b32 v11, 96, v8
    v_xor_b32 v12, 128, v8
    v_xor_b32 v13, 160, v8
    v_xor_b32 v14, 192, v8
    v_xor_b32 v15, 224, v8
    v_mov_b32 v24, 0
    v_mov_b32 v25, 0
    v_mov_b32 v26, 0
    v_mov_b32 v27, 0
    v_mov_b32 v32, 0
    v_mov_b32 v33, 0
    s_lshl_b32 s49, s2, 19
    s_mov_b32 s48, 0
    s_mov_b32 s54, 0
    s_mov_b32 s36, s6
    s_and_b32 s37, s7, 0xffff
    s_mov_b32 s38, 134217728
    s_mov_b32 s39, 0x20000
    s_branch L_over0
P_0:
    s_barrier
    s_branch P_6
L_over0:
L_slot:
    s_waitcnt lgkmcnt(0)
    v_min3_i32 v28, v24, v25, v26
    v_readfirstlane_b32 s52, v32
    v_min_i32 v28, v28, v27
    v_readfirstlane_b32 s53, v33
    v_readfirstlane_b32 s50, v28
    s_mov_b32 m0, s54
    s_add_u32 s50, s50, 9
    s_cmp_gt_i32 s50, s48
    s_cbranch_scc0 L_full
    s_sub_u32 s51, s48, 1
    v_mov_b32 v29, s51
    s_mov_b32 s29, 4194304
L_body0:
    s_waitcnt vmcnt(18)
    buffer_load_dwordx4 v8, s[36:39], s49 offen offset:0 nt lds
    s_waitcnt vmcnt(18)
    buffer_load_dwordx4 v9, s[36:39], s49 offen offset:1024 nt lds
    s_waitcnt vmcnt(18)
    buffer_load_dwordx4 v10, s[36:39], s49 offen offset:2048 nt lds
    ds_write_b32 v1, v29
    s_waitcnt vmcnt(18)
    buffer_load_dwordx4 v11, s[36:39], s49 offen offset:3072 nt lds
    s_add_u32 s49, s49, 4096
    s_add_u32 m0, m0, 4096
    s_waitcnt vmcnt(18)
    buffer_load_dwordx4 v12, s[36:39], s49 offen offset:0 nt lds
    s_cmp_eq_u32 s48, 0
    s_cbranch_scc1 L_bar0
L_bar0r:
    s_waitcnt vmcnt(18)
    buffer_load_dwordx4 v13, s[36:39], s49 offen offset:1024 nt lds
    s_waitcnt vmcnt(18)
    buffer_load_dwordx4 v14, s[36:39], s49 offen offset:2048 nt lds
    s_waitcnt vmcnt(18)
    buffer_load_dwordx4 v15, s[36:39], s49 offen offset:3072 nt lds
    s_add_u32 s49, s49, 4096
    s_add_u32 m0, m0, 4096
    s_waitcnt vmcnt(18)
    buffer_load_dwordx4 v8, s[36:39], s49 offen offset:0 nt lds
    s_waitcnt vmcnt(18)
    buffer_load_dwordx4 v9, s[36:39], s49 offen offset:1024 nt lds
    s_waitcnt vmcnt(18)
    buffer_load_dwordx4 v10, s[36:39], s49 offen offset:2048 nt lds
    s_waitcnt vmcnt(18)
    buffer_load_dwordx4 v11, s[36:39], s49 offen offset:3072 nt lds
    ds_read_b128 v[24:27], v1 offset:16
    ds_read_b64 v[32:33], v1 offset:40
    s_add_u32 s49, s49, 4096
    s_add_u32 m0, m0, 4096
    s_waitcnt vmcnt(18)
    buffer_load_dwordx4 v12, s[36:39], s49 offen offset:0 nt lds
    s_waitcnt vmcnt(18)
    buffer_load_dwordx4 v13, s[36:39], s49 offen offset:1024 nt lds
    s_waitcnt vmcnt(18)
    buffer_load_dwordx4 v14, s[36:39], s49 offen offset:2048 nt lds
    s_waitcnt vmcnt(18)
    buffer_load_dwordx4 v15, s[36:39], s49 offen offset:3072 nt lds
    s_add_u32 s49, s49, 4096
L_next:
    s_add_u32 s54, s54, 16384
    s_cmp_eq_u32 s54, 147456
    s_cselect_b32 s54, 0, s54
    s_add_u32 s48, s48, 1
    s_and_b32 s50, s48, 31
    s_cbranch_scc1 L_slot
    s_cmp_eq_u32 s48, 64
    s_cbranch_scc1 L_ltail
    s_mov_b32 s36, s8
    s_and_b32 s37, s9, 0xffff
    s_lshl_b32 s49, s2, 19
    v_lshlrev_b32 v28, 1, v2
    v_xor_b32 v28, v28, v3
    v_lshl_or_b32 v8, v28, 4, v30
    v_xor_b32 v9, 64, v8
    v_xor_b32 v10, 128, v8
    v_xor_b32 v11, 192, v8
    v_xor_b32 v12, 0, v8
    v_xor_b32 v13, 64, v8
    v_xor_b32 v14, 128, v8
    v_xor_b32 v15, 192, v8
    s_branch L_slot
L_bar0:
    s_barrier
    s_branch L_bar0r
L_full:
    ds_read_b128 v[24:27], v1 offset:16
    s_sub_u32 s29, s29, 1
    s_cbranch_scc0 L_slot
    s_endpgm
L_ltail:
    v_mov_b32 v20, 63
    v_mov_b32 v21, 64
    v_mov_b32 v22, 62
    s_mov_b32 s44, s20
    s_and_b32 s45, s21, 0xffff
    s_mov_b32 s46, 1605632
    s_mov_b32 s47, 0x20000
    s_bitcmp0_b32 s2, 2
    s_cbranch_scc1 L_lt_f
    s_mov_b32 s40, s12
    s_and_b32 s41, s13, 0xffff
    s_mov_b32 s42, 3670016
    s_mov_b32 s43, 0x20000
    v_lshrrev_b32 v16, 3, v0
    v_and_b32 v18, 6, v16
    v_and_b32 v19, 7, v0
    v_xor_b32 v18, v18, v19
    v_mul_u32_u24 v16, 896, v16
    v_lshl_add_u32 v16, v18, 4, v16
    s_and_b32 s50, s2, 3
    s_lshl_b32 s50, s50, 2
    s_bfe_u32 s51, s2, 0x20003
    s_add_u32 s50, s50, s51
    s_mul_i32 s49, s50, 229376
    s_lshr_b32 s50, s2, 5
    s_lshl_b32 s50, s50, 7
    s_add_u32 s49, s49, s50
    s_branch L_lt_c
L_lt_f:
    s_mov_b32 s36, s16
    s_and_b32 s37, s17, 0xffff
    s_mov_b32 s38, 1605632
    s_mov_b32 s39, 0x20000
    s_mov_b32 s40, s18
    s_and_b32 s41, s19, 0xffff
    s_mov_b32 s42, 1605632
    s_mov_b32 s43, 0x20000
    s_and_b32 s51, s2, 3
    s_mul_i32 s51, s51, 28
    s_lshr_b32 s50, s2, 3
    s_add_u32 s52, s50, s51
    v_lshrrev_b32 v16, 1, v0
    v_mul_u32_u24 v16, 3584, v16
    v_and_b32 v17, 1, v0
    v_lshl_add_u32 v16, v17, 4, v16
    v_lshlrev_b32 v17, 4, v0
    s_lshl_b32 s49, s52, 5
    s_mul_i32 s55, s52, 14336
L_lt_c:
    s_cmp_ge_u32 s2, 224
    s_cbranch_scc1 L_lt_ffn
    s_mov_b32 s29, 4194304
    s_mov_b32 m0, 16384
L_lt_chk:
    s_waitcnt lgkmcnt(0)
    v_min3_i32 v28, v24, v25, v26
    v_min_i32 v28, v28, v27
    s_nop 0
    v_readfirstlane_b32 s50, v28
    s_nop 0
    s_cmp_ge_i32 s50, 58
    s_cbranch_scc1 L_lt_go
    ds_read_b128 v[24:27], v1 offset:16
    s_sub_u32 s29, s29, 1
    s_cbranch_scc0 L_lt_chk
    s_endpgm
L_lt_go:
    s_bitcmp0_b32 s2, 2
    s_cbranch_scc1 L_lt_ffn
    s_waitcnt vmcnt(16)
    ds_write_b32 v1, v20
    s_mov_b32 s50, 31
L_lt_o:
    buffer_load_dwordx4 v16, s[40:43], s49 offen nt lds
    s_add_u32 s49, s49, 7168
    s_add_u32 m0, m0, 1024
    s_sub_u32 s50, s50, 1
    s_cbranch_scc0 L_lt_o
    s_waitcnt vmcnt(32)
    ds_write_b32 v1, v21
    s_branch L_lt_done
L_lt_ffn:
    s_waitcnt vmcnt(16)
    ds_write_b32 v1, v20
    s_waitcnt vmcnt(0)
    ds_write_b32 v1, v21
    s_cmp_ge_u32 s2, 224
    s_cbranch_scc1 L_lt_done
    s_mov_b32 s50, 13
L_lt_g:
    buffer_load_dwordx4 v16, s[36:39], s49 offen  lds
    s_add_u32 m0, m0, 14336
    s_nop 0
    buffer_load_dwordx4 v16, s[40:43], s49 offen  lds
    s_add_u32 s49, s49, 114688
    s_sub_u32 m0, m0, 13312
    s_sub_u32 s50, s50, 1
    s_cbranch_scc0 L_lt_g
    s_mov_b32 m0, 45056
    s_mov_b32 s50, 13
L_lt_d:
    buffer_load_dwordx4 v17, s[44:47], s55 offen nt lds
    s_add_u32 s55, s55, 1024
    s_add_u32 m0, m0, 1024
    s_sub_u32 s50, s50, 1
    s_cbranch_scc0 L_lt_d
L_lt_done:
    s_waitcnt vmcnt(0) lgkmcnt(0)
    s_barrier
    s_branch L_fin
.fill 6, 4, 0xbf810000
P_1:
    s_barrier
    s_branch P_7
L_qprod:
    s_waitcnt lgkmcnt(0)
    s_load_dword s28, s[26:27], 0
    s_mov_b32 s32, s26
    s_and_b32 s33, s27, 0xffff
    s_mov_b32 s34, 1114112
    s_mov_b32 s35, 0x20000
    v_and_b32 v2, 15, v0
    v_lshrrev_b32 v3, 4, v0
    s_sub_u32 s30, s3, 1
    s_bfe_u32 s50, s2, 0x20001
    s_lshr_b32 s51, s2, 3
    s_and_b32 s53, s2, 1
    s_lshl_b32 s53, s53, 5
    s_add_u32 s51, s51, s53
    v_lshlrev_b32 v44, 4, v0
    v_add_u32 v44, 145408, v44
    v_and_b32 v4, 1, v0
    v_mul_u32_u24 v45, 896, v4
    v_lshl_add_u32 v45, v3, 3, v45
    s_mul_i32 s52, s50, 224
    s_add_u32 s52, s52, 145408
    v_add_u32 v45, s52, v45
    v_lshrrev_b32 v5, 2, v0
    v_lshlrev_b32 v5, 7, v5
    v_and_b32 v6, 3, v0
    v_lshl_add_u32 v5, v6, 3, v5
    v_bfe_u32 v6, v0, 3, 2
    v_lshl_add_u32 v5, v6, 5, v5
    v_xor_b32 v40, 0, v5
    v_add_u32 v40, 131072, v40
    v_xor_b32 v41, 32, v5
    v_add_u32 v41, 131072, v41
    v_xor_b32 v42, 64, v5
    v_add_u32 v42, 131072, v42
    v_xor_b32 v43, 96, v5
    v_add_u32 v43, 131072, v43
    v_lshlrev_b32 v46, 17, v4
    v_lshrrev_b32 v5, 2, v2
    v_lshl_add_u32 v46, v5, 7, v46
    v_lshl_add_u32 v46, v3, 5, v46
    v_bfe_u32 v6, v2, 1, 1
    v_lshl_add_u32 v46, v6, 4, v46
    s_lshr_b32 s52, s51, 2
    s_lshl_b32 s52, s52, 13
    s_lshl_b32 s53, s50, 11
    s_add_u32 s52, s52, s53
    s_and_b32 s53, s51, 3
    s_lshl_b32 s53, s53, 9
    s_add_u32 s52, s52, s53
    s_add_u32 s52, s52, 65536
    v_cmp_eq_u32 s[58:59], 1, v6
    s_mov_b32 s54, 0x3b124925
    s_waitcnt vmcnt(0)
    v_lshlrev_b32 v16, 16, v8
    v_and_b32 v17, 0xffff0000, v8
    v_lshlrev_b32 v18, 16, v9
    v_and_b32 v19, 0xffff0000, v9
    v_lshlrev_b32 v20, 16, v10
    v_and_b32 v21, 0xffff0000, v10
    v_lshlrev_b32 v22, 16, v11
    v_and_b32 v23, 0xffff0000, v11
    v_lshlrev_b32 v24, 16, v12
    v_and_b32 v25, 0xffff0000, v12
    v_lshlrev_b32 v26, 16, v13
    v_and_b32 v27, 0xffff0000, v13
    v_lshlrev_b32 v28, 16, v14
    v_and_b32 v29, 0xffff0000, v14
    v_lshlrev_b32 v30, 16, v15
    v_and_b32 v31, 0xffff0000, v15
    v_pk_add_f32 v[48:49], v[16:17], v[18:19]
    v_pk_add_f32 v[50:51], v[20:21], v[22:23]
    v_pk_add_f32 v[48:49], v[48:49], v[50:51]
    v_add_f32 v32, v48, v49
    v_pk_add_f32 v[48:49], v[24:25], v[26:27]
    v_pk_add_f32 v[50:51], v[28:29], v[30:31]
    v_pk_add_f32 v[48:49], v[48:49], v[50:51]
    v_add_f32 v34, v48, v49
    v_add_f32_dpp v32, v32, v32 quad_perm:[1,0,3,2] row_mask:0xf bank_mask:0xf
    s_nop 0
    v_add_f32_dpp v34, v34, v34 quad_perm:[1,0,3,2] row_mask:0xf bank_mask:0xf
    v_add_f32_dpp v32, v32, v32 quad_perm:[2,3,0,1] row_mask:0xf bank_mask:0xf
    s_nop 0
    v_add_f32_dpp v34, v34, v34 quad_perm:[2,3,0,1] row_mask:0xf bank_mask:0xf
    v_add_f32_dpp v32, v32, v32 row_half_mirror row_mask:0xf bank_mask:0xf
    s_nop 0
    v_add_f32_dpp v34, v34, v34 row_half_mirror row_mask:0xf bank_mask:0xf
    v_add_f32_dpp v32, v32, v32 row_mirror row_mask:0xf bank_mask:0xf
    s_nop 0
    v_add_f32_dpp v34, v34, v34 row_mirror row_mask:0xf bank_mask:0xf
    v_mov_b32 v48, v32
    v_mov_b32 v49, v34
    s_nop 0
    v_permlane16_swap_b32 v32, v48
    v_permlane16_swap_b32 v34, v49
    v_add_f32 v32, v32, v48
    v_add_f32 v34, v34, v49
    v_mov_b32 v48, v32
    v_mov_b32 v49, v34
    s_nop 0
    v_permlane32_swap_b32 v32, v48
    v_permlane32_swap_b32 v34, v49
    v_add_f32 v32, v32, v48
    v_add_f32 v34, v34, v49
    v_mul_f32 v32, s54, v32
    v_mul_f32 v34, s54, v34
    v_mov_b32 v33, v32
    v_mov_b32 v35, v34
    v_pk_add_f32 v[48:49], v[16:17], v[32:33] neg_lo:[0,1] neg_hi:[0,1]
    v_pk_add_f32 v[50:51], v[18:19], v[32:33] neg_lo:[0,1] neg_hi:[0,1]
    v_pk_add_f32 v[52:53], v[20:21], v[32:33] neg_lo:[0,1] neg_hi:[0,1]
    v_pk_add_f32 v[54:55], v[22:23], v[32:33] neg_lo:[0,1] neg_hi:[0,1]
    v_pk_mul_f32 v[56:57], v[48:49], v[48:49]
    v_pk_fma_f32 v[56:57], v[50:51], v[50:51], v[56:57]
    v_pk_fma_f32 v[56:57], v[52:53], v[52:53], v[56:57]
    v_pk_fma_f32 v[56:57], v[54:55], v[54:55], v[56:57]
    v_add_f32 v56, v56, v57
    v_cndmask_b32 v36, 0, v56, s[56:57]
    v_pk_add_f32 v[48:49], v[24:25], v[34:35] neg_lo:[0,1] neg_hi:[0,1]
    v_pk_add_f32 v[50:51], v[26:27], v[34:35] neg_lo:[0,1] neg_hi:[0,1]
    v_pk_add_f32 v[52:53], v[28:29], v[34:35] neg_lo:[0,1] neg_hi:[0,1]
    v_pk_add_f32 v[54:55], v[30:31], v[34:35] neg_lo:[0,1] neg_hi:[0,1]
    v_pk_mul_f32 v[56:57], v[48:49], v[48:49]
    v_pk_fma_f32 v[56:57], v[50:51], v[50:51], v[56:57]
    v_pk_fma_f32 v[56:57], v[52:53], v[52:53], v[56:57]
    v_pk_fma_f32 v[56:57], v[54:55], v[54:55], v[56:57]
    v_add_f32 v56, v56, v57
    v_cndmask_b32 v38, 0, v56, s[56:57]
    s_branch L_over2
.fill 77, 4, 0xbf810000
P_2:
    s_barrier
    s_branch L_w1
L_over2:
    v_add_f32_dpp v36, v36, v36 quad_perm:[1,0,3,2] row_mask:0xf bank_mask:0xf
    v_add_f32_dpp v38, v38, v38 quad_perm:[1,0,3,2] row_mask:0xf bank_mask:0xf
    s_nop 0
    v_add_f32_dpp v36, v36, v36 quad_perm:[2,3,0,1] row_mask:0xf bank_mask:0xf
    v_add_f32_dpp v38, v38, v38 quad_perm:[2,3,0,1] row_mask:0xf bank_mask:0xf
    s_nop 0
    v_add_f32_dpp v36, v36, v36 row_half_mirror row_mask:0xf bank_mask:0xf
    v_add_f32_dpp v38, v38, v38 row_half_mirror row_mask:0xf bank_mask:0xf
    s_nop 0
    v_add_f32_dpp v36, v36, v36 row_mirror row_mask:0xf bank_mask:0xf
    v_add_f32_dpp v38, v38, v38 row_mirror row_mask:0xf bank_mask:0xf
    v_mov_b32 v48, v36
    v_mov_b32 v49, v38
    s_nop 0
    v_permlane16_swap_b32 v36, v48
    v_permlane16_swap_b32 v38, v49
    v_add_f32 v36, v36, v48
    v_add_f32 v38, v38, v49
    v_mov_b32 v48, v36
    v_mov_b32 v49, v38
    s_nop 0
    v_permlane32_swap_b32 v36, v48
    v_permlane32_swap_b32 v38, v49
    v_add_f32 v36, v36, v48
    v_add_f32 v38, v38, v49
    v_mul_f32 v36, s54, v36
    v_mul_f32 v38, s54, v38
    v_cvt_pk_bf16_f32 v48, v32, v34
    v_lshlrev_b32 v32, 16, v48
    v_and_b32 v34, 0xffff0000, v48
    v_cvt_pk_bf16_f32 v48, v36, v38
    v_lshlrev_b32 v36, 16, v48
    v_and_b32 v38, 0xffff0000, v48
    v_add_f32 v36, 0x3727c5ac, v36
    v_add_f32 v38, 0x3727c5ac, v38
    v_mov_b32 v33, v32
    v_mov_b32 v35, v34
    v_cvt_pk_bf16_f32 v48, v36, v38
    v_lshlrev_b32 v36, 16, v48
    v_and_b32 v38, 0xffff0000, v48
    v_sqrt_f32 v36, v36
    v_sqrt_f32 v38, v38
    v_pk_add_f32 v[16:17], v[16:17], v[32:33] neg_lo:[0,1] neg_hi:[0,1]
    v_pk_add_f32 v[18:19], v[18:19], v[32:33] neg_lo:[0,1] neg_hi:[0,1]
    v_pk_add_f32 v[20:21], v[20:21], v[32:33] neg_lo:[0,1] neg_hi:[0,1]
    v_pk_add_f32 v[22:23], v[22:23], v[32:33] neg_lo:[0,1] neg_hi:[0,1]
    v_pk_add_f32 v[24:25], v[24:25], v[34:35] neg_lo:[0,1] neg_hi:[0,1]
    v_pk_add_f32 v[26:27], v[26:27], v[34:35] neg_lo:[0,1] neg_hi:[0,1]
    v_pk_add_f32 v[28:29], v[28:29], v[34:35] neg_lo:[0,1] neg_hi:[0,1]
    v_pk_add_f32 v[30:31], v[30:31], v[34:35] neg_lo:[0,1] neg_hi:[0,1]
    v_cvt_pk_bf16_f32 v48, v36, v38
    v_lshlrev_b32 v36, 16, v48
    v_and_b32 v38, 0xffff0000, v48
    v_rcp_f32 v36, v36
    v_rcp_f32 v38, v38
    v_cvt_pk_bf16_f32 v48, v16, v17
    v_cvt_pk_bf16_f32 v49, v18, v19
    v_lshlrev_b32 v16, 16, v48
    v_and_b32 v17, 0xffff0000, v48
    v_lshlrev_b32 v18, 16, v49
    v_and_b32 v19, 0xffff0000, v49
    v_cvt_pk_bf16_f32 v48, v20, v21
    v_cvt_pk_bf16_f32 v49, v22, v23
    v_lshlrev_b32 v20, 16, v48
    v_and_b32 v21, 0xffff0000, v48
    v_lshlrev_b32 v22, 16, v49
    v_and_b32 v23, 0xffff0000, v49
    v_cvt_pk_bf16_f32 v48, v24, v25
    v_cvt_pk_bf16_f32 v49, v26, v27
    v_lshlrev_b32 v24, 16, v48
    v_and_b32 v25, 0xffff0000, v48
    v_lshlrev_b32 v26, 16, v49
    v_and_b32 v27, 0xffff0000, v49
    v_cvt_pk_bf16_f32 v48, v28, v29
    v_cvt_pk_bf16_f32 v49, v30, v31
    v_lshlrev_b32 v28, 16, v48
    v_and_b32 v29, 0xffff0000, v48
    v_lshlrev_b32 v30, 16, v49
    v_and_b32 v31, 0xffff0000, v49
    v_mov_b32 v37, v36
    v_mov_b32 v39, v38
    v_pk_mul_f32 v[16:17], v[16:17], v[36:37]
    v_pk_mul_f32 v[18:19], v[18:19], v[36:37]
    v_pk_mul_f32 v[20:21], v[20:21], v[36:37]
    v_pk_mul_f32 v[22:23], v[22:23], v[36:37]
    v_pk_mul_f32 v[24:25], v[24:25], v[38:39]
    v_pk_mul_f32 v[26:27], v[26:27], v[38:39]
    v_pk_mul_f32 v[28:29], v[28:29], v[38:39]
    v_pk_mul_f32 v[30:31], v[30:31], v[38:39]
    v_cvt_pk_bf16_f32 v8, v16, v17
    v_cvt_pk_bf16_f32 v9, v18, v19
    v_cvt_pk_bf16_f32 v10, v20, v21
    v_cvt_pk_bf16_f32 v11, v22, v23
    v_cvt_pk_bf16_f32 v12, v24, v25
    v_cvt_pk_bf16_f32 v13, v26, v27
    v_cvt_pk_bf16_f32 v14, v28, v29
    v_cvt_pk_bf16_f32 v15, v30, v31
    s_mov_b64 exec, s[56:57]
    ds_write_b128 v44, v[8:11]
    ds_write_b128 v44, v[12:15] offset:896
    s_mov_b64 exec, -1
    ds_read_b64 v[16:17], v45 offset:0
    ds_read_b64 v[18:19], v45 offset:32
    ds_read_b64 v[20:21], v45 offset:64
    ds_read_b64 v[22:23], v45 offset:96
    ds_read_b64 v[24:25], v45 offset:128
    ds_read_b64 v[26:27], v45 offset:160
    ds_read_b64 v[28:29], v45 offset:192
    s_mov_b32 s29, 4194304
L_lp2:
    ds_read_b32 v7, v1 offset:0
    s_sub_u32 s29, s29, 1
    s_cbranch_scc1 L_end
    s_waitcnt lgkmcnt(0)
    v_readfirstlane_b32 s31, v7
    s_nop 0
    s_cmp_gt_i32 s31, -1
    s_cbranch_scc0 L_lp2
L_ok1:
    ds_read_b64_tr_b16 v[64:65], v40 offset:0
    ds_read_b64_tr_b16 v[78:79], v41 offset:0
    ds_read_b64_tr_b16 v[92:93], v42 offset:0
    ds_read_b64_tr_b16 v[106:107], v43 offset:0
    ds_read_b64_tr_b16 v[66:67], v40 offset:2048
    ds_read_b64_tr_b16 v[80:81], v41 offset:2048
    ds_read_b64_tr_b16 v[94:95], v42 offset:2048
    ds_read_b64_tr_b16 v[108:109], v43 offset:2048
    ds_read_b64_tr_b16 v[68:69], v40 offset:4096
    ds_read_b64_tr_b16 v[82:83], v41 offset:4096
    ds_read_b64_tr_b16 v[96:97], v42 offset:4096
    ds_read_b64_tr_b16 v[110:111], v43 offset:4096
    ds_read_b64_tr_b16 v[70:71], v40 offset:6144
    ds_read_b64_tr_b16 v[84:85], v41 offset:6144
    ds_read_b64_tr_b16 v[98:99], v42 offset:6144
    ds_read_b64_tr_b16 v[112:113], v43 offset:6144
    ds_read_b64_tr_b16 v[72:73], v40 offset:8192
    ds_read_b64_tr_b16 v[86:87], v41 offset:8192
    ds_read_b64_tr_b16 v[100:101], v42 offset:8192
    ds_read_b64_tr_b16 v[114:115], v43 offset:8192
    ds_read_b64_tr_b16 v[74:75], v40 offset:10240
    ds_read_b64_tr_b16 v[88:89], v41 offset:10240
    ds_read_b64_tr_b16 v[102:103], v42 offset:10240
    ds_read_b64_tr_b16 v[116:117], v43 offset:10240
    ds_read_b64_tr_b16 v[76:77], v40 offset:12288
    ds_read_b64_tr_b16 v[90:91], v41 offset:12288
    ds_read_b64_tr_b16 v[104:105], v42 offset:12288
    ds_read_b64_tr_b16 v[118:119], v43 offset:12288
    s_mul_i32 s28, s28, 1664525
    s_add_u32 s28, s28, 1013904223
    s_branch L_over3
.fill 23, 4, 0xbf810000
P_3:
    s_barrier
    s_branch P_4
L_over3:
    s_mov_b32 s60, 0x000f000f
    s_mov_b32 s61, 0x000f000f
    v_mov_b32 v7, 32
    v_mov_b32 v9, s28
    v_mov_b32 v11, s28
    s_waitcnt lgkmcnt(0)
    ds_write_b32 v1, v7 offset:20
    v_mfma_f32_16x16x16_bf16 v[48:51], v[64:65], v[16:17], 0
    v_mfma_f32_16x16x16_bf16 v[52:55], v[78:79], v[16:17], 0
    v_mfma_f32_16x16x16_bf16 v[56:59], v[92:93], v[16:17], 0
    v_mfma_f32_16x16x16_bf16 v[60:63], v[106:107], v[16:17], 0
    v_mfma_f32_16x16x16_bf16 v[48:51], v[66:67], v[18:19], v[48:51]
    v_mfma_f32_16x16x16_bf16 v[52:55], v[80:81], v[18:19], v[52:55]
    v_mfma_f32_16x16x16_bf16 v[56:59], v[94:95], v[18:19], v[56:59]
    v_mfma_f32_16x16x16_bf16 v[60:63], v[108:109], v[18:19], v[60:63]
    v_mfma_f32_16x16x16_bf16 v[48:51], v[68:69], v[20:21], v[48:51]
    v_mfma_f32_16x16x16_bf16 v[52:55], v[82:83], v[20:21], v[52:55]
    v_mfma_f32_16x16x16_bf16 v[56:59], v[96:97], v[20:21], v[56:59]
    v_mfma_f32_16x16x16_bf16 v[60:63], v[110:111], v[20:21], v[60:63]
    v_mfma_f32_16x16x16_bf16 v[48:51], v[70:71], v[22:23], v[48:51]
    v_mfma_f32_16x16x16_bf16 v[52:55], v[84:85], v[22:23], v[52:55]
    v_mfma_f32_16x16x16_bf16 v[56:59], v[98:99], v[22:23], v[56:59]
    v_mfma_f32_16x16x16_bf16 v[60:63], v[112:113], v[22:23], v[60:63]
    v_mfma_f32_16x16x16_bf16 v[48:51], v[72:73], v[24:25], v[48:51]
    v_mfma_f32_16x16x16_bf16 v[52:55], v[86:87], v[24:25], v[52:55]
    v_mfma_f32_16x16x16_bf16 v[56:59], v[100:101], v[24:25], v[56:59]
    v_mfma_f32_16x16x16_bf16 v[60:63], v[114:115], v[24:25], v[60:63]
    v_mfma_f32_16x16x16_bf16 v[48:51], v[74:75], v[26:27], v[48:51]
    v_mfma_f32_16x16x16_bf16 v[52:55], v[88:89], v[26:27], v[52:55]
    v_mfma_f32_16x16x16_bf16 v[56:59], v[102:103], v[26:27], v[56:59]
    v_mfma_f32_16x16x16_bf16 v[60:63], v[116:117], v[26:27], v[60:63]
    v_mfma_f32_16x16x16_bf16 v[48:51], v[76:77], v[28:29], v[48:51]
    v_mfma_f32_16x16x16_bf16 v[52:55], v[90:91], v[28:29], v[52:55]
    v_mfma_f32_16x16x16_bf16 v[56:59], v[104:105], v[28:29], v[56:59]
    v_mfma_f32_16x16x16_bf16 v[60:63], v[118:119], v[28:29], v[60:63]
    s_lshl_b64 s[60:61], s[60:61], 4
    s_nop 4
    v_cndmask_b32 v48, v48, v52, s[60:61]
    v_cndmask_b32 v49, v49, v53, s[60:61]
    v_cndmask_b32 v50, v50, v54, s[60:61]
    v_cndmask_b32 v51, v51, v55, s[60:61]
    s_lshl_b64 s[60:61], s[60:61], 4
    v_cndmask_b32 v48, v48, v56, s[60:61]
    v_cndmask_b32 v49, v49, v57, s[60:61]
    v_cndmask_b32 v50, v50, v58, s[60:61]
    v_cndmask_b32 v51, v51, v59, s[60:61]
    s_lshl_b64 s[60:61], s[60:61], 4
    v_cndmask_b32 v48, v48, v60, s[60:61]
    v_cndmask_b32 v49, v49, v61, s[60:61]
    v_cndmask_b32 v50, v50, v62, s[60:61]
    v_cndmask_b32 v51, v51, v63, s[60:61]
    v_cndmask_b32 v8, v48, v50, s[58:59]
    v_cndmask_b32 v10, v49, v51, s[58:59]
    buffer_store_dwordx4 v[8:11], v46, s[32:35], s52 offen sc1
    s_waitcnt vmcnt(0)
    ds_write_b32 v1, v7 offset:36
    s_branch L_vwait
L_w1:
    s_waitcnt lgkmcnt(0)
    s_load_dword s28, s[26:27], 0
    s_mov_b32 s32, s26
    s_and_b32 s33, s27, 0xffff
    s_mov_b32 s34, 1114112
    s_mov_b32 s35, 0x20000
    v_and_b32 v2, 15, v0
    v_lshrrev_b32 v3, 4, v0
    s_sub_u32 s30, s3, 1
    s_lshr_b32 s48, s2, 3
    s_lshl_b32 s48, s48, 13
    s_add_u32 s48, s48, 65536
    s_add_u32 s49, s48, 4096
    v_lshlrev_b32 v4, 4, v0
    v_xor_b32 v5, v3, v2
    v_lshlrev_b32 v6, 9, v2
    v_lshl_or_b32 v8, v5, 4, v6
    v_xor_b32 v9, 64, v8
    v_xor_b32 v10, 128, v8
    v_xor_b32 v11, 192, v8
    v_lshlrev_b32 v14, 2, v0
    v_lshlrev_b32 v15, 4, v3
    v_add_u32 v14, 147520, v14
    v_add_u32 v15, 147520, v15
    s_mov_b32 s29, 4194304
L_lp4:
    ds_read_b32 v7, v1 offset:36
    s_sub_u32 s29, s29, 1
    s_cbranch_scc1 L_end
    s_waitcnt lgkmcnt(0)
    v_readfirstlane_b32 s31, v7
    s_nop 0
    s_cmp_gt_i32 s31, 0
    s_cbranch_scc0 L_lp4
L_ok3:
    s_mul_i32 s28, s28, 1664525
    s_add_u32 s28, s28, 1013904223
    s_mov_b32 s29, 131072
L_qpoll:
    buffer_load_dwordx4 v[32:35], v4, s[32:35], s48 offen offset:0 sc1
    buffer_load_dwordx4 v[36:39], v4, s[32:35], s48 offen offset:1024 sc1
    buffer_load_dwordx4 v[40:43], v4, s[32:35], s48 offen offset:2048 sc1
    buffer_load_dwordx4 v[44:47], v4, s[32:35], s48 offen offset:3072 sc1
    buffer_load_dwordx4 v[48:51], v4, s[32:35], s49 offen offset:0 sc1
    buffer_load_dwordx4 v[52:55], v4, s[32:35], s49 offen offset:1024 sc1
    buffer_load_dwordx4 v[56:59], v4, s[32:35], s49 offen offset:2048 sc1
    buffer_load_dwordx4 v[60:63], v4, s[32:35], s49 offen offset:3072 sc1
    s_sub_u32 s29, s29, 1
    s_cbranch_scc1 L_end
    v_mov_b32 v7, 0
    s_waitcnt vmcnt(7)
    v_xor_b32 v12, s28, v33
    v_xor_b32 v13, s28, v35
    v_or3_b32 v7, v7, v12, v13
    s_waitcnt vmcnt(6)
    v_xor_b32 v12, s28, v37
    v_xor_b32 v13, s28, v39
    v_or3_b32 v7, v7, v12, v13
    s_waitcnt vmcnt(5)
    v_xor_b32 v12, s28, v41
    v_xor_b32 v13, s28, v43
    v_or3_b32 v7, v7, v12, v13
    s_waitcnt vmcnt(4)
    v_xor_b32 v12, s28, v45
    v_xor_b32 v13, s28, v47
    v_or3_b32 v7, v7, v12, v13
    s_waitcnt vmcnt(3)
    v_xor_b32 v12, s28, v49
    v_xor_b32 v13, s28, v51
    v_or3_b32 v7, v7, v12, v13
    s_waitcnt vmcnt(2)
    v_xor_b32 v12, s28, v53
    v_xor_b32 v13, s28, v55
    v_or3_b32 v7, v7, v12, v13
    s_waitcnt vmcnt(1)
    v_xor_b32 v12, s28, v57
    v_xor_b32 v13, s28, v59
    v_or3_b32 v7, v7, v12, v13
    s_waitcnt vmcnt(0)
    v_xor_b32 v12, s28, v61
    v_xor_b32 v13, s28, v63
    v_or3_b32 v7, v7, v12, v13
    v_cmp_ne_u32 vcc, 0, v7
    s_nop 0
    s_cbranch_vccnz L_qpoll
L_qok:
    v_add_f32 v32, v32, v40
    v_add_f32 v48, v48, v56
    v_add_f32 v32, v32, v48
    v_add_f32 v34, v34, v42
    v_add_f32 v50, v50, v58
    v_add_f32 v34, v34, v50
    v_cvt_pk_bf16_f32 v12, v32, v34
    v_add_f32 v36, v36, v44
    v_add_f32 v52, v52, v60
    v_add_f32 v36, v36, v52
    v_add_f32 v38, v38, v46
    v_add_f32 v54, v54, v62
    v_add_f32 v38, v38, v54
    v_cvt_pk_bf16_f32 v13, v36, v38
    ds_write_b32 v14, v12
    ds_write_b32 v14, v13 offset:256
    ds_read_b128 v[32:35], v15 offset:0
    ds_read_b128 v[36:39], v15 offset:64
    ds_read_b128 v[40:43], v15 offset:128
    ds_read_b128 v[44:47], v15 offset:192
    ds_read_b128 v[48:51], v15 offset:256
    ds_read_b128 v[52:55], v15 offset:320
    ds_read_b128 v[56:59], v15 offset:384
    ds_read_b128 v[60:63], v15 offset:448
    s_mov_b32 s48, 0
    s_mov_b32 s31, 0
    s_mov_b32 s55, 0
    s_mov_b32 s52, 0x00010001
    s_mov_b32 s53, 0x00010001
    s_branch L_over4
.fill 8, 4, 0xbf810000
P_4:
    s_branch P_5
L_over4:
L_k:
    v_add_u32 v12, s55, v8
    v_add_u32 v13, s55, v9
    v_add_u32 v14, s55, v10
    v_add_u32 v15, s55, v11
    s_cmp_gt_i32 s31, s48
    s_cbranch_scc1 L_ok5
    s_mov_b32 s29, 4194304
L_lp6:
    ds_read_b32 v7, v1 offset:0
    s_sub_u32 s29, s29, 1
    s_cbranch_scc1 L_end
    s_waitcnt lgkmcnt(0)
    v_readfirstlane_b32 s31, v7
    s_nop 0
    s_cmp_gt_i32 s31, s48
    s_cbranch_scc0 L_lp6
L_ok5:
    ds_read_b128 v[64:67], v12 offset:0
    ds_read_b128 v[68:71], v12 offset:8192
    ds_read_b128 v[72:75], v13 offset:0
    ds_read_b128 v[76:79], v13 offset:8192
    ds_read_b128 v[80:83], v14 offset:0
    ds_read_b128 v[84:87], v14 offset:8192
    ds_read_b128 v[88:91], v15 offset:0
    ds_read_b128 v[92:95], v15 offset:8192
    ds_read_b128 v[96:99], v12 offset:256
    ds_read_b128 v[100:103], v12 offset:8448
    ds_read_b128 v[104:107], v13 offset:256
    ds_read_b128 v[108:111], v13 offset:8448
    ds_read_b128 v[112:115], v14 offset:256
    ds_read_b128 v[116:119], v14 offset:8448
    ds_read_b128 v[120:123], v15 offset:256
    ds_read_b128 v[124:127], v15 offset:8448
    s_add_u32 s48, s48, 1
    v_mov_b32 v7, s48
    s_add_u32 s55, s55, 16384
    s_cmp_eq_u32 s55, 147456
    s_cselect_b32 s55, 0, s55
    s_waitcnt lgkmcnt(12)
    v_mfma_f32_16x16x32_bf16 v[128:131], v[64:67], v[32:35], 0
    v_mfma_f32_16x16x32_bf16 v[132:135], v[68:71], v[32:35], 0
    v_mfma_f32_16x16x32_bf16 v[128:131], v[72:75], v[36:39], v[128:131]
    v_mfma_f32_16x16x32_bf16 v[132:135], v[76:79], v[36:39], v[132:135]
    s_waitcnt lgkmcnt(8)
    v_mfma_f32_16x16x32_bf16 v[128:131], v[80:83], v[40:43], v[128:131]
    v_mfma_f32_16x16x32_bf16 v[132:135], v[84:87], v[40:43], v[132:135]
    v_mfma_f32_16x16x32_bf16 v[128:131], v[88:91], v[44:47], v[128:131]
    v_mfma_f32_16x16x32_bf16 v[132:135], v[92:95], v[44:47], v[132:135]
    s_waitcnt lgkmcnt(4)
    v_mfma_f32_16x16x32_bf16 v[128:131], v[96:99], v[48:51], v[128:131]
    v_mfma_f32_16x16x32_bf16 v[132:135], v[100:103], v[48:51], v[132:135]
    v_mfma_f32_16x16x32_bf16 v[128:131], v[104:107], v[52:55], v[128:131]
    v_mfma_f32_16x16x32_bf16 v[132:135], v[108:111], v[52:55], v[132:135]
    s_waitcnt lgkmcnt(0)
    ds_write_b32 v1, v7 offset:16
    v_mfma_f32_16x16x32_bf16 v[128:131], v[112:115], v[56:59], v[128:131]
    v_mfma_f32_16x16x32_bf16 v[132:135], v[116:119], v[56:59], v[132:135]
    v_mfma_f32_16x16x32_bf16 v[128:131], v[120:123], v[60:63], v[128:131]
    v_mfma_f32_16x16x32_bf16 v[132:135], v[124:127], v[60:63], v[132:135]
    s_nop 6
    v_cndmask_b32 v16, v16, v128, s[52:53]
    v_cndmask_b32 v17, v17, v129, s[52:53]
    v_cndmask_b32 v18, v18, v130, s[52:53]
    v_cndmask_b32 v19, v19, v131, s[52:53]
    v_cndmask_b32 v20, v20, v132, s[52:53]
    v_cndmask_b32 v21, v21, v133, s[52:53]
    v_cndmask_b32 v22, v22, v134, s[52:53]
    v_cndmask_b32 v23, v23, v135, s[52:53]
    s_lshl_b64 s[52:53], s[52:53], 1
    s_and_b32 s50, s48, 15
    s_cbranch_scc1 L_k
    s_cmp_eq_u32 s48, 32
    s_cbranch_scc1 L_kdone
    v_mov_b32 v24, v16
    v_mov_b32 v25, v17
    v_mov_b32 v26, v18
    v_mov_b32 v27, v19
    v_mov_b32 v28, v20
    v_mov_b32 v29, v21
    v_mov_b32 v30, v22
    v_mov_b32 v31, v23
    s_mov_b32 s52, 0x00010001
    s_mov_b32 s53, 0x00010001
    s_branch L_k
.fill 142, 4, 0xbf810000
P_5:
    s_branch L_w5
L_kdone:
    v_cvt_pk_bf16_f32 v6, v16, v17
    v_cvt_pk_bf16_f32 v7, v18, v19
    v_lshlrev_b32 v16, 16, v6
    v_and_b32 v17, 0xffff0000, v6
    v_lshlrev_b32 v18, 16, v7
    v_and_b32 v19, 0xffff0000, v7
    v_cvt_pk_bf16_f32 v6, v20, v21
    v_cvt_pk_bf16_f32 v7, v22, v23
    v_lshlrev_b32 v20, 16, v6
    v_and_b32 v21, 0xffff0000, v6
    v_lshlrev_b32 v22, 16, v7
    v_and_b32 v23, 0xffff0000, v7
    v_cvt_pk_bf16_f32 v6, v24, v25
    v_cvt_pk_bf16_f32 v7, v26, v27
    v_lshlrev_b32 v24, 16, v6
    v_and_b32 v25, 0xffff0000, v6
    v_lshlrev_b32 v26, 16, v7
    v_and_b32 v27, 0xffff0000, v7
    v_cvt_pk_bf16_f32 v6, v28, v29
    v_cvt_pk_bf16_f32 v7, v30, v31
    v_lshlrev_b32 v28, 16, v6
    v_and_b32 v29, 0xffff0000, v6
    v_lshlrev_b32 v30, 16, v7
    v_and_b32 v31, 0xffff0000, v7
    v_max3_f32 v12, v16, v17, v18
    v_max3_f32 v13, v24, v25, v26
    v_max3_f32 v12, v12, v19, v20
    v_max3_f32 v13, v13, v27, v28
    v_max3_f32 v12, v12, v21, v22
    v_max3_f32 v13, v13, v29, v30
    v_max3_f32 v12, v12, v23, v31
    v_max_f32 v12, v12, v13
    s_nop 1
    v_max_f32_dpp v12, v12, v12 quad_perm:[1,0,3,2] row_mask:0xf bank_mask:0xf
    s_nop 1
    v_max_f32_dpp v12, v12, v12 quad_perm:[2,3,0,1] row_mask:0xf bank_mask:0xf
    s_nop 1
    v_max_f32_dpp v12, v12, v12 row_half_mirror row_mask:0xf bank_mask:0xf
    s_nop 1
    v_max_f32_dpp v12, v12, v12 row_mirror row_mask:0xf bank_mask:0xf
    v_mov_b32 v13, v12
    s_nop 1
    v_permlane16_swap_b32 v12, v13
    v_max_f32 v12, v12, v13
    v_mov_b32 v13, v12
    s_nop 1
    v_permlane32_swap_b32 v12, v13
    v_max_f32 v12, v12, v13
    s_mov_b32 s54, 0x3db8aa3b
    v_sub_f32 v64, v16, v12
    v_sub_f32 v65, v17, v12
    v_sub_f32 v66, v18, v12
    v_sub_f32 v67, v19, v12
    v_sub_f32 v68, v20, v12
    v_sub_f32 v69, v21, v12
    v_sub_f32 v70, v22, v12
    v_sub_f32 v71, v23, v12
    v_sub_f32 v72, v24, v12
    v_sub_f32 v73, v25, v12
    v_sub_f32 v74, v26, v12
    v_sub_f32 v75, v27, v12
    v_sub_f32 v76, v28, v12
    v_sub_f32 v77, v29, v12
    v_sub_f32 v78, v30, v12
    v_sub_f32 v79, v31, v12
    v_mul_f32 v64, s54, v64
    v_mul_f32 v65, s54, v65
    v_mul_f32 v66, s54, v66
    v_mul_f32 v67, s54, v67
    v_mul_f32 v68, s54, v68
    v_mul_f32 v69, s54, v69
    v_mul_f32 v70, s54, v70
    v_mul_f32 v71, s54, v71
    v_mul_f32 v72, s54, v72
    v_mul_f32 v73, s54, v73
    v_mul_f32 v74, s54, v74
    v_mul_f32 v75, s54, v75
    v_mul_f32 v76, s54, v76
    v_mul_f32 v77, s54, v77
    v_mul_f32 v78, s54, v78
    v_mul_f32 v79, s54, v79
    v_exp_f32 v64, v64
    v_exp_f32 v65, v65
    v_exp_f32 v66, v66
    v_exp_f32 v67, v67
    v_exp_f32 v68, v68
    v_exp_f32 v69, v69
    v_exp_f32 v70, v70
    v_exp_f32 v71, v71
    v_exp_f32 v72, v72
    v_exp_f32 v73, v73
    v_exp_f32 v74, v74
    v_exp_f32 v75, v75
    v_exp_f32 v76, v76
    v_exp_f32 v77, v77
    v_exp_f32 v78, v78
    v_exp_f32 v79, v79
    v_pk_add_f32 v[64:65], v[64:65], v[72:73]
    v_pk_add_f32 v[66:67], v[66:67], v[74:75]
    v_pk_add_f32 v[68:69], v[68:69], v[76:77]
    v_pk_add_f32 v[70:71], v[70:71], v[78:79]
    v_pk_add_f32 v[64:65], v[64:65], v[68:69]
    v_pk_add_f32 v[66:67], v[66:67], v[70:71]
    v_pk_add_f32 v[64:65], v[64:65], v[66:67]
    v_add_f32 v14, v64, v65
    s_nop 1
    v_add_f32_dpp v14, v14, v14 quad_perm:[1,0,3,2] row_mask:0xf bank_mask:0xf
    s_nop 1
    v_add_f32_dpp v14, v14, v14 quad_perm:[2,3,0,1] row_mask:0xf bank_mask:0xf
    s_nop 1
    v_add_f32_dpp v14, v14, v14 row_half_mirror row_mask:0xf bank_mask:0xf
    s_nop 1
    v_add_f32_dpp v14, v14, v14 row_mirror row_mask:0xf bank_mask:0xf
    v_mov_b32 v13, v14
    s_nop 1
    v_permlane16_swap_b32 v14, v13
    v_add_f32 v14, v14, v13
    v_mov_b32 v13, v14
    s_nop 1
    v_permlane32_swap_b32 v14, v13
    v_add_f32 v14, v14, v13
    v_mov_b32 v13, s28
    v_mov_b32 v15, s28
    s_lshl_b32 s50, s2, 7
    s_add_u32 s50, s50, 32768
    v_mov_b32 v7, 0
    s_mov_b64 exec, 1
    buffer_store_dwordx4 v[12:15], v7, s[32:35], s50 offen sc1
    s_mov_b64 exec, -1
    s_and_b32 s50, s50, 0xfffffc00
    v_and_b32 v7, 7, v0
    v_lshlrev_b32 v7, 7, v7
    s_mov_b32 s29, 131072
    s_branch L_over6
.fill 94, 4, 0xbf810000
P_6:
    s_branch L_w3a
L_over6:
L_mlpoll:
    buffer_load_dwordx4 v[64:67], v7, s[32:35], s50 offen sc1
    s_sub_u32 s29, s29, 1
    s_cbranch_scc1 L_end
    s_waitcnt vmcnt(0)
    v_xor_b32 v68, s28, v65
    v_xor_b32 v69, s28, v67
    v_or_b32 v68, v68, v69
    v_cmp_ne_u32 vcc, 0, v68
    s_nop 0
    s_cbranch_vccnz L_mlpoll
L_mlok:
    v_mov_b32 v12, v64
    s_nop 1
    v_max_f32_dpp v12, v12, v12 quad_perm:[1,0,3,2] row_mask:0xf bank_mask:0xf
    s_nop 1
    v_max_f32_dpp v12, v12, v12 quad_perm:[2,3,0,1] row_mask:0xf bank_mask:0xf
    s_nop 1
    v_max_f32_dpp v12, v12, v12 row_half_mirror row_mask:0xf bank_mask:0xf
    v_sub_f32 v14, v64, v12
    v_mul_f32 v14, s54, v14
    v_exp_f32 v14, v14
    s_nop 0
    v_mul_f32 v14, v14, v66
    s_nop 1
    v_add_f32_dpp v14, v14, v14 quad_perm:[1,0,3,2] row_mask:0xf bank_mask:0xf
    s_nop 1
    v_add_f32_dpp v14, v14, v14 quad_perm:[2,3,0,1] row_mask:0xf bank_mask:0xf
    s_nop 1
    v_add_f32_dpp v14, v14, v14 row_half_mirror row_mask:0xf bank_mask:0xf
    v_rcp_f32 v4, v14
    v_sub_f32 v64, v16, v12
    v_sub_f32 v65, v17, v12
    v_sub_f32 v66, v18, v12
    v_sub_f32 v67, v19, v12
    v_sub_f32 v68, v20, v12
    v_sub_f32 v69, v21, v12
    v_sub_f32 v70, v22, v12
    v_sub_f32 v71, v23, v12
    v_sub_f32 v72, v24, v12
    v_sub_f32 v73, v25, v12
    v_sub_f32 v74, v26, v12
    v_sub_f32 v75, v27, v12
    v_sub_f32 v76, v28, v12
    v_sub_f32 v77, v29, v12
    v_sub_f32 v78, v30, v12
    v_sub_f32 v79, v31, v12
    v_mul_f32 v64, s54, v64
    v_mul_f32 v65, s54, v65
    v_mul_f32 v66, s54, v66
    v_mul_f32 v67, s54, v67
    v_mul_f32 v68, s54, v68
    v_mul_f32 v69, s54, v69
    v_mul_f32 v70, s54, v70
    v_mul_f32 v71, s54, v71
    v_mul_f32 v72, s54, v72
    v_mul_f32 v73, s54, v73
    v_mul_f32 v74, s54, v74
    v_mul_f32 v75, s54, v75
    v_mul_f32 v76, s54, v76
    v_mul_f32 v77, s54, v77
    v_mul_f32 v78, s54, v78
    v_mul_f32 v79, s54, v79
    v_exp_f32 v64, v64
    v_exp_f32 v65, v65
    v_exp_f32 v66, v66
    v_exp_f32 v67, v67
    v_exp_f32 v68, v68
    v_exp_f32 v69, v69
    v_exp_f32 v70, v70
    v_exp_f32 v71, v71
    v_exp_f32 v72, v72
    v_exp_f32 v73, v73
    v_exp_f32 v74, v74
    v_exp_f32 v75, v75
    v_exp_f32 v76, v76
    v_exp_f32 v77, v77
    v_exp_f32 v78, v78
    v_exp_f32 v79, v79
    v_fma_f32 v15, -v14, v4, 1.0
    v_fma_f32 v4, v15, v4, v4
    v_mov_b32 v5, v4
    v_pk_mul_f32 v[64:65], v[64:65], v[4:5]
    v_pk_mul_f32 v[66:67], v[66:67], v[4:5]
    v_pk_mul_f32 v[68:69], v[68:69], v[4:5]
    v_pk_mul_f32 v[70:71], v[70:71], v[4:5]
    v_pk_mul_f32 v[72:73], v[72:73], v[4:5]
    v_pk_mul_f32 v[74:75], v[74:75], v[4:5]
    v_pk_mul_f32 v[76:77], v[76:77], v[4:5]
    v_pk_mul_f32 v[78:79], v[78:79], v[4:5]
    v_cvt_pk_bf16_f32 v80, v64, v65
    v_cvt_pk_bf16_f32 v81, v66, v67
    v_cvt_pk_bf16_f32 v82, v68, v69
    v_cvt_pk_bf16_f32 v83, v70, v71
    v_cvt_pk_bf16_f32 v84, v72, v73
    v_cvt_pk_bf16_f32 v85, v74, v75
    v_cvt_pk_bf16_f32 v86, v76, v77
    v_cvt_pk_bf16_f32 v87, v78, v79
    v_lshlrev_b32 v7, 6, v2
    v_lshl_add_u32 v7, v3, 4, v7
    v_add_u32 v7, 148032, v7
    v_mov_b32 v12, 1
    ds_write_b128 v7, v[84:87]
    ds_write_b128 v7, v[80:83] offset:1024
    ds_write_b32 v1, v12 offset:32
    s_branch L_vphase
L_w5:
    s_endpgm
L_w3a:
    s_waitcnt lgkmcnt(0)
    s_load_dword s28, s[26:27], 0
    s_mov_b32 s32, s26
    s_and_b32 s33, s27, 0xffff
    s_mov_b32 s34, 1114112
    s_mov_b32 s35, 0x20000
    v_and_b32 v2, 15, v0
    v_lshrrev_b32 v3, 4, v0
    s_sub_u32 s30, s3, 1
    v_mov_b32 v8, 0x7fd5a5a5
    v_mov_b32 v9, 0x7fd5a5a5
    v_mov_b32 v10, 0x7fd5a5a5
    v_mov_b32 v11, 0x7fd5a5a5
    v_lshlrev_b32 v4, 4, v0
    s_mul_i32 s48, s2, 3072
    s_add_u32 s48, s48, 327680
    buffer_store_dwordx4 v[8:11], v4, s[32:35], s48 offen offset:0 sc1
    buffer_store_dwordx4 v[8:11], v4, s[32:35], s48 offen offset:1024 sc1
    buffer_store_dwordx4 v[8:11], v4, s[32:35], s48 offen offset:2048 sc1
    s_branch P_8
L_w3b:
    s_waitcnt vmcnt(0) lgkmcnt(0)
    s_mul_i32 s28, s28, 1664525
    s_add_u32 s28, s28, 1013904223
    v_mov_b32 v8, s28
    v_mov_b32 v4, 0
    s_and_b32 s48, s2, 63
    s_lshl_b32 s48, s48, 7
    s_lshr_b32 s49, s2, 6
    s_lshl_b32 s49, s49, 2
    s_add_u32 s48, s48, s49
    s_add_u32 s48, s48, 8192
    s_mov_b64 exec, 1
    buffer_store_dword v8, v4, s[32:35], s48 offen sc1
    s_mov_b64 exec, -1
    s_branch L_vwait
L_w4b:
    s_waitcnt lgkmcnt(0)
    s_load_dword s28, s[26:27], 0
    s_mov_b32 s32, s26
    s_and_b32 s33, s27, 0xffff
    s_mov_b32 s34, 1114112
    s_mov_b32 s35, 0x20000
    v_and_b32 v2, 15, v0
    v_lshrrev_b32 v3, 4, v0
    s_sub_u32 s30, s3, 1
    s_mov_b32 s29, 4194304
L_lp8:
    ds_read_b32 v7, v1 offset:0
    s_sub_u32 s29, s29, 1
    s_cbranch_scc1 L_end
    s_waitcnt lgkmcnt(0)
    v_readfirstlane_b32 s31, v7
    s_nop 0
    s_cmp_gt_i32 s31, 20
    s_cbranch_scc0 L_lp8
L_ok7:
    s_mul_i32 s28, s28, 1664525
    s_add_u32 s28, s28, 1013904223
    v_lshlrev_b32 v4, 7, v0
    s_mov_b32 s48, 8192
    s_mov_b32 s29, 131072
L_clpoll:
    buffer_load_dwordx4 v[8:11], v4, s[32:35], s48 offen sc1
    s_sub_u32 s29, s29, 1
    s_cbranch_scc1 L_end
    s_waitcnt vmcnt(0)
    v_xor_b32 v8, s28, v8
    v_xor_b32 v9, s28, v9
    v_xor_b32 v10, s28, v10
    v_xor_b32 v11, s28, v11
    v_or3_b32 v8, v8, v9, v10
    v_or_b32 v8, v8, v11
    v_cmp_ne_u32 vcc, 0, v8
    s_nop 0
    s_cbranch_vccnz L_clpoll
L_vwait:
    s_mov_b32 s29, 4194304
L_lp10:
    ds_read_b32 v7, v1 offset:32
    s_sub_u32 s29, s29, 1
    s_cbranch_scc1 L_end
    s_waitcnt lgkmcnt(0)
    v_readfirstlane_b32 s31, v7
    s_nop 0
    s_cmp_gt_i32 s31, 0
    s_cbranch_scc0 L_lp10
L_ok9:
    s_mov_b32 s31, 0
    s_branch L_over7
.fill 23, 4, 0xbf810000
P_7:
    s_branch P_9
L_over7:
L_vphase:
    v_lshrrev_b32 v4, 2, v0
    v_and_b32 v5, 7, v4
    v_lshlrev_b32 v4, 9, v4
    v_and_b32 v6, 3, v0
    v_lshl_add_u32 v4, v6, 3, v4
    s_lshl_b32 s50, s30, 2
    v_xor_b32 v5, s50, v5
    v_lshl_add_u32 v8, v5, 5, v4
    v_xor_b32 v9, 32, v8
    v_xor_b32 v10, 64, v8
    v_xor_b32 v11, 96, v8
    v_lshlrev_b32 v16, 4, v3
    v_lshl_add_u32 v18, v2, 6, v16
    v_add_u32 v16, 148032, v16
    v_add_u32 v17, s50, v1
    s_lshl_b32 s49, s2, 10
    s_lshl_b32 s50, s30, 8
    s_add_u32 s49, s49, s50
    s_add_u32 s49, s49, 327680
    v_cmp_eq_u32 s[56:57], 0, v2
    v_mov_b32 v48, 0
    v_cmp_eq_u32 s[58:59], 1, v2
    v_mov_b32 v49, 0
    v_cmp_eq_u32 s[60:61], 2, v2
    v_mov_b32 v50, 0
    v_cmp_eq_u32 s[62:63], 3, v2
    v_mov_b32 v51, 0
    s_mov_b32 s48, 32
    s_mov_b32 s55, 81920
L_v:
    ds_read_b128 v[20:23], v16
    v_add_u32 v16, 64, v16
    v_add_u32 v12, s55, v8
    v_add_u32 v13, s55, v9
    v_add_u32 v14, s55, v10
    v_add_u32 v15, s55, v11
    s_add_u32 s55, s55, 16384
    s_cmp_eq_u32 s55, 147456
    s_cselect_b32 s55, 0, s55
    s_waitcnt lgkmcnt(0)
    v_cndmask_b32 v64, 0, v20, s[56:57]
    v_cndmask_b32 v65, 0, v21, s[56:57]
    v_cndmask_b32 v66, 0, v22, s[56:57]
    v_cndmask_b32 v67, 0, v23, s[56:57]
    v_cndmask_b32 v68, 0, v20, s[58:59]
    v_cndmask_b32 v69, 0, v21, s[58:59]
    v_cndmask_b32 v70, 0, v22, s[58:59]
    v_cndmask_b32 v71, 0, v23, s[58:59]
    v_cndmask_b32 v72, 0, v20, s[60:61]
    v_cndmask_b32 v73, 0, v21, s[60:61]
    v_cndmask_b32 v74, 0, v22, s[60:61]
    v_cndmask_b32 v75, 0, v23, s[60:61]
    v_cndmask_b32 v76, 0, v20, s[62:63]
    v_cndmask_b32 v77, 0, v21, s[62:63]
    v_cndmask_b32 v78, 0, v22, s[62:63]
    v_cndmask_b32 v79, 0, v23, s[62:63]
    s_cmp_gt_i32 s31, s48
    s_cbranch_scc1 L_ok11
    s_mov_b32 s29, 4194304
L_lp12:
    ds_read_b32 v7, v1 offset:0
    s_sub_u32 s29, s29, 1
    s_cbranch_scc1 L_end
    s_waitcnt lgkmcnt(0)
    v_readfirstlane_b32 s31, v7
    s_nop 0
    s_cmp_gt_i32 s31, s48
    s_cbranch_scc0 L_lp12
L_ok11:
    ds_read_b64_tr_b16 v[32:33], v12 offset:0
    ds_read_b64_tr_b16 v[34:35], v12 offset:8192
    ds_read_b64_tr_b16 v[36:37], v13 offset:0
    ds_read_b64_tr_b16 v[38:39], v13 offset:8192
    ds_read_b64_tr_b16 v[40:41], v14 offset:0
    ds_read_b64_tr_b16 v[42:43], v14 offset:8192
    ds_read_b64_tr_b16 v[44:45], v15 offset:0
    ds_read_b64_tr_b16 v[46:47], v15 offset:8192
    s_add_u32 s48, s48, 1
    v_mov_b32 v7, s48
    s_waitcnt lgkmcnt(6)
    v_mfma_f32_16x16x32_bf16 v[48:51], v[32:35], v[64:67], v[48:51]
    s_waitcnt lgkmcnt(4)
    v_mfma_f32_16x16x32_bf16 v[48:51], v[36:39], v[68:71], v[48:51]
    s_waitcnt lgkmcnt(2)
    v_mfma_f32_16x16x32_bf16 v[48:51], v[40:43], v[72:75], v[48:51]
    s_waitcnt lgkmcnt(0)
    v_mfma_f32_16x16x32_bf16 v[48:51], v[44:47], v[76:79], v[48:51]
    ds_write_b32 v17, v7 offset:16
    s_cmp_lt_u32 s48, 64
    s_cbranch_scc1 L_v
L_vend:
    s_mov_b32 exec_lo, 0x000f000f
    s_mov_b32 exec_hi, 0x000f000f
    s_nop 2
    buffer_store_dwordx4 v[48:51], v18, s[32:35], s49 offen sc1
    s_mov_b64 exec, -1
    s_cmp_ge_u32 s2, 224
    s_cbranch_scc1 L_idle
    s_bitcmp0_b32 s2, 2
    s_cbranch_scc1 L_ffn
    v_lshrrev_b32 v5, 2, v0
    v_lshlrev_b32 v5, 7, v5
    v_and_b32 v6, 3, v0
    v_lshl_add_u32 v5, v6, 3, v5
    v_bfe_u32 v6, v0, 3, 2
    v_xor_b32 v6, s30, v6
    v_lshl_add_u32 v5, v6, 5, v5
    v_lshrrev_b32 v8, 5, v0
    v_lshlrev_b32 v8, 12, v8
    v_and_b32 v9, 31, v0
    v_lshl_add_u32 v8, v9, 4, v8
    s_lshr_b32 s50, s30, 1
    s_lshl_b32 s48, s50, 4
    s_and_b32 s51, s2, 3
    s_lshl_b32 s51, s51, 2
    s_bfe_u32 s52, s2, 0x20003
    s_add_u32 s51, s51, s52
    s_add_u32 s48, s48, s51
    s_lshl_b32 s48, s48, 13
    s_and_b32 s52, s30, 1
    s_lshl_b32 s53, s52, 9
    s_add_u32 s48, s48, s53
    s_add_u32 s48, s48, 327680
    v_lshrrev_b32 v10, 3, v9
    v_lshlrev_b32 v10, 6, v10
    v_and_b32 v11, 3, v9
    v_lshl_add_u32 v10, v11, 4, v10
    v_bfe_u32 v11, v9, 2, 1
    v_lshl_add_u32 v10, v11, 3, v10
    v_lshrrev_b32 v11, 5, v0
    v_lshl_add_u32 v10, v11, 2, v10
    s_lshl_b32 s53, s30, 8
    s_add_u32 s53, s53, 150080
    v_add_u32 v10, s53, v10
    v_and_b32 v11, 1, v0
    v_lshlrev_b32 v12, 9, v11
    v_lshl_add_u32 v12, v3, 4, v12
    v_add_u32 v12, 150080, v12
    v_lshlrev_b32 v13, 6, v11
    v_lshl_add_u32 v13, v3, 4, v13
    s_mul_i32 s49, s51, 3584
    s_lshr_b32 s53, s2, 5
    s_lshl_b32 s53, s53, 2
    s_add_u32 s53, s53, s30
    s_lshl_b32 s53, s53, 7
    s_add_u32 s49, s49, s53
    s_add_u32 s49, s49, 589824
    s_branch L_over8
.fill 62, 4, 0xbf810000
P_8:
    s_branch P_10
L_over8:
    s_barrier
    ds_read_b64_tr_b16 v[64:65], v5 offset:16384
    ds_read_b64_tr_b16 v[66:67], v5 offset:18432
    ds_read_b64_tr_b16 v[68:69], v5 offset:20480
    ds_read_b64_tr_b16 v[70:71], v5 offset:22528
    ds_read_b64_tr_b16 v[72:73], v5 offset:24576
    ds_read_b64_tr_b16 v[74:75], v5 offset:26624
    ds_read_b64_tr_b16 v[76:77], v5 offset:28672
    ds_read_b64_tr_b16 v[78:79], v5 offset:30720
    ds_read_b64_tr_b16 v[80:81], v5 offset:32768
    ds_read_b64_tr_b16 v[82:83], v5 offset:34816
    ds_read_b64_tr_b16 v[84:85], v5 offset:36864
    ds_read_b64_tr_b16 v[86:87], v5 offset:38912
    ds_read_b64_tr_b16 v[88:89], v5 offset:40960
    ds_read_b64_tr_b16 v[90:91], v5 offset:43008
    ds_read_b64_tr_b16 v[92:93], v5 offset:45056
    ds_read_b64_tr_b16 v[94:95], v5 offset:47104
    s_mov_b32 s29, 131072
    s_mov_b64 s[56:57], -1
    s_mov_b64 s[58:59], -1
    s_mov_b64 s[60:61], -1
    s_mov_b64 s[62:63], -1
L_h1:
    s_or_b64 exec, s[56:57], 1
    buffer_load_dwordx4 v[32:35], v8, s[32:35], s48 offen offset:0 sc1
    s_or_b64 exec, s[58:59], 1
    buffer_load_dwordx4 v[36:39], v8, s[32:35], s48 offen offset:1024 sc1
    s_or_b64 exec, s[60:61], 1
    buffer_load_dwordx4 v[40:43], v8, s[32:35], s48 offen offset:2048 sc1
    s_or_b64 exec, s[62:63], 1
    buffer_load_dwordx4 v[44:47], v8, s[32:35], s48 offen offset:3072 sc1
    s_mov_b64 exec, -1
    s_waitcnt vmcnt(2)
    v_pk_add_f32 v[16:17], v[32:33], v[36:37]
    v_pk_add_f32 v[18:19], v[34:35], v[38:39]
    s_waitcnt vmcnt(0)
    v_pk_add_f32 v[20:21], v[40:41], v[44:45]
    v_pk_add_f32 v[22:23], v[42:43], v[46:47]
    v_pk_add_f32 v[16:17], v[16:17], v[20:21]
    v_pk_add_f32 v[18:19], v[18:19], v[22:23]
    v_pk_add_f32 v[20:21], v[16:17], v[18:19]
    v_cmp_u_f32 vcc, v20, v21
    s_nop 0
    s_cbranch_vccz L_h1ok
    v_pk_add_f32 v[20:21], v[32:33], v[34:35]
    v_cmp_u_f32 s[56:57], v20, v21
    v_pk_add_f32 v[22:23], v[36:37], v[38:39]
    v_cmp_u_f32 s[58:59], v22, v23
    v_pk_add_f32 v[20:21], v[40:41], v[42:43]
    v_cmp_u_f32 s[60:61], v20, v21
    v_pk_add_f32 v[22:23], v[44:45], v[46:47]
    v_cmp_u_f32 s[62:63], v22, v23
    s_sub_u32 s29, s29, 1
    s_cbranch_scc0 L_h1
L_h1ok:
    v_permlane32_swap_b32 v16, v18
    v_permlane32_swap_b32 v17, v19
    v_pk_add_f32 v[16:17], v[16:17], v[18:19]
    v_cvt_pk_bf16_f32 v20, v16, v17
    ds_write_b32 v10, v20
    s_waitcnt lgkmcnt(0)
    s_barrier
    ds_read_b128 v[96:99], v12 offset:0
    ds_read_b128 v[100:103], v12 offset:64
    ds_read_b128 v[104:107], v12 offset:128
    ds_read_b128 v[108:111], v12 offset:192
    ds_read_b128 v[112:115], v12 offset:256
    ds_read_b128 v[116:119], v12 offset:320
    ds_read_b128 v[120:123], v12 offset:384
    ds_read_b128 v[124:127], v12 offset:448
    s_waitcnt lgkmcnt(7)
    v_mfma_f32_16x16x32_bf16 v[24:27], v[64:67], v[96:99], 0
    s_waitcnt lgkmcnt(6)
    v_mfma_f32_16x16x32_bf16 v[24:27], v[68:71], v[100:103], v[24:27]
    s_waitcnt lgkmcnt(5)
    v_mfma_f32_16x16x32_bf16 v[24:27], v[72:75], v[104:107], v[24:27]
    s_waitcnt lgkmcnt(4)
    v_mfma_f32_16x16x32_bf16 v[24:27], v[76:79], v[108:111], v[24:27]
    s_waitcnt lgkmcnt(3)
    v_mfma_f32_16x16x32_bf16 v[24:27], v[80:83], v[112:115], v[24:27]
    s_waitcnt lgkmcnt(2)
    v_mfma_f32_16x16x32_bf16 v[24:27], v[84:87], v[116:119], v[24:27]
    s_waitcnt lgkmcnt(1)
    v_mfma_f32_16x16x32_bf16 v[24:27], v[88:91], v[120:123], v[24:27]
    s_waitcnt lgkmcnt(0)
    v_mfma_f32_16x16x32_bf16 v[24:27], v[92:95], v[124:127], v[24:27]
    s_mov_b32 exec_lo, 0x00030003
    s_mov_b32 exec_hi, 0x00030003
    s_nop 5
    buffer_store_dwordx4 v[24:27], v13, s[32:35], s49 offen sc1
    s_branch L_fin
L_ffn:
    s_mov_b32 s40, s4
    s_and_b32 s41, s5, 0xffff
    s_mov_b32 s42, 1792
    s_mov_b32 s43, 0x20000
    s_mov_b32 s44, s22
    s_and_b32 s45, s23, 0xffff
    s_mov_b32 s46, 1792
    s_mov_b32 s47, 0x20000
    s_and_b32 s51, s2, 3
    s_mul_i32 s51, s51, 28
    s_lshr_b32 s50, s2, 3
    s_add_u32 s52, s50, s51
    v_lshrrev_b32 v8, 5, v0
    v_and_b32 v9, 31, v0
    v_cmp_gt_u32 vcc, 28, v9
    v_mul_u32_u24 v10, 896, v8
    v_lshl_add_u32 v10, v9, 3, v10
    s_mul_i32 s50, s30, 224
    v_add_u32 v10, s50, v10
    v_mov_b32 v11, 2146435072
    v_cndmask_b32 v10, v11, v10, vcc
    buffer_load_dwordx2 v[14:15], v10, s[40:43], 0 offen
    v_lshrrev_b32 v12, 2, v9
    v_lshlrev_b32 v12, 7, v12
    v_lshl_add_u32 v12, v8, 6, v12
    v_and_b32 v6, 3, v0
    v_lshl_add_u32 v12, v6, 4, v12
    v_cndmask_b32 v40, v11, v12, vcc
    v_add_u32 v41, 7168, v40
    v_add_u32 v42, 14336, v40
    v_add_u32 v43, 21504, v40
    v_add_u32 v44, 28672, v40
    v_add_u32 v45, 35840, v40
    v_add_u32 v46, 43008, v40
    v_add_u32 v47, 50176, v40
    s_mul_i32 s48, s30, 896
    s_add_u32 s48, s48, 589824
    v_lshlrev_b32 v24, 5, v8
    v_add_u32 v24, 151104, v24
    s_lshl_b32 s50, s30, 3
    v_add_u32 v25, s50, v24
    s_lshl_b32 s50, s30, 9
    s_add_u32 s50, s50, 151168
    v_lshrrev_b32 v26, 3, v0
    v_lshlrev_b32 v26, 6, v26
    v_lshl_add_u32 v26, v6, 4, v26
    v_bfe_u32 v11, v0, 2, 1
    v_lshl_add_u32 v26, v11, 3, v26
    v_add_u32 v26, s50, v26
    v_lshlrev_b32 v27, 8, v11
    v_lshl_add_u32 v27, v3, 4, v27
    v_add_u32 v27, s50, v27
    v_lshlrev_b32 v28, 6, v11
    v_lshl_add_u32 v28, v3, 4, v28
    v_add_u32 v29, 153216, v28
    s_lshl_b32 s50, s30, 8
    v_lshl_add_u32 v31, v6, 2, v29
    v_add_u32 v29, s50, v29
    v_lshrrev_b32 v7, 3, v2
    v_lshl_add_u32 v7, v7, 2, v6
    v_mul_u32_u24 v30, 14336, v7
    v_add_u32 v30, v30, v28
    s_lshl_b32 s49, s52, 7
    s_mul_i32 s50, s30, 100352
    s_add_u32 s49, s49, s50
    s_add_u32 s49, s49, 647168
    s_mul_i32 s50, s30, 3584
    v_lshl_add_u32 v4, v0, 3, s50
    v_lshrrev_b32 v5, 2, v0
    v_lshlrev_b32 v13, 7, v5
    v_lshl_add_u32 v13, v6, 4, v13
    v_mul_u32_u24 v5, 896, v5
    v_lshl_add_u32 v5, v6, 3, v5
    s_mul_i32 s50, s30, 224
    v_add_u32 v5, s50, v5
    v_mov_b32 v142, 0
    v_mov_b32 v143, 0
    v_mov_b32 v158, 0
    v_mov_b32 v159, 0
    s_branch L_over9
.fill 3, 4, 0xbf810000
P_9:
    s_branch P_11
L_over9:
    s_waitcnt vmcnt(0)
    s_barrier
    ds_read_b64_tr_b16 v[128:129], v4 offset:16384
    ds_read_b64_tr_b16 v[144:145], v4 offset:30720
    ds_read_b64_tr_b16 v[130:131], v4 offset:16896
    ds_read_b64_tr_b16 v[146:147], v4 offset:31232
    ds_read_b64_tr_b16 v[132:133], v4 offset:17408
    ds_read_b64_tr_b16 v[148:149], v4 offset:31744
    ds_read_b64_tr_b16 v[134:135], v4 offset:17920
    ds_read_b64_tr_b16 v[150:151], v4 offset:32256
    ds_read_b64_tr_b16 v[136:137], v4 offset:18432
    ds_read_b64_tr_b16 v[152:153], v4 offset:32768
    ds_read_b64_tr_b16 v[138:139], v4 offset:18944
    ds_read_b64_tr_b16 v[154:155], v4 offset:33280
    ds_read_b64_tr_b16 v[140:141], v4 offset:19456
    ds_read_b64_tr_b16 v[156:157], v4 offset:33792
    ds_read_b64_tr_b16 v[160:161], v5 offset:45056
    ds_read_b64_tr_b16 v[162:163], v5 offset:45088
    ds_read_b64_tr_b16 v[164:165], v5 offset:45120
    ds_read_b64_tr_b16 v[166:167], v5 offset:45152
    ds_read_b64_tr_b16 v[168:169], v5 offset:45184
    ds_read_b64_tr_b16 v[170:171], v5 offset:45216
    ds_read_b64_tr_b16 v[172:173], v5 offset:45248
    v_lshlrev_b32 v52, 16, v14
    v_and_b32 v53, 0xffff0000, v14
    v_lshlrev_b32 v54, 16, v15
    v_and_b32 v55, 0xffff0000, v15
    s_mov_b32 s54, 0x3b124925
    s_mov_b32 s96, 0
    s_mov_b32 s97, 0x80000000
    buffer_load_dwordx4 v[176:179], v40, s[32:35], s48 offen offset:0 sc1
    buffer_load_dwordx4 v[180:183], v40, s[32:35], s48 offen offset:3584 sc1
    buffer_load_dwordx4 v[184:187], v41, s[32:35], s48 offen offset:0 sc1
    buffer_load_dwordx4 v[188:191], v41, s[32:35], s48 offen offset:3584 sc1
    buffer_load_dwordx4 v[192:195], v42, s[32:35], s48 offen offset:0 sc1
    buffer_load_dwordx4 v[196:199], v42, s[32:35], s48 offen offset:3584 sc1
    buffer_load_dwordx4 v[200:203], v43, s[32:35], s48 offen offset:0 sc1
    buffer_load_dwordx4 v[204:207], v43, s[32:35], s48 offen offset:3584 sc1
    buffer_load_dwordx4 v[208:211], v44, s[32:35], s48 offen offset:0 sc1
    buffer_load_dwordx4 v[212:215], v44, s[32:35], s48 offen offset:3584 sc1
    buffer_load_dwordx4 v[216:219], v45, s[32:35], s48 offen offset:0 sc1
    buffer_load_dwordx4 v[220:223], v45, s[32:35], s48 offen offset:3584 sc1
    buffer_load_dwordx4 v[224:227], v46, s[32:35], s48 offen offset:0 sc1
    buffer_load_dwordx4 v[228:231], v46, s[32:35], s48 offen offset:3584 sc1
    buffer_load_dwordx4 v[232:235], v47, s[32:35], s48 offen offset:0 sc1
    buffer_load_dwordx4 v[236:239], v47, s[32:35], s48 offen offset:3584 sc1
    s_mov_b32 s29, 131072
    s_mov_b64 s[4:5], -1
    s_mov_b64 s[6:7], -1
    s_mov_b64 s[8:9], -1
    s_mov_b64 s[10:11], -1
    s_mov_b64 s[12:13], -1
    s_mov_b64 s[14:15], -1
    s_mov_b64 s[16:17], -1
    s_mov_b64 s[18:19], -1
L_h2:
    s_mov_b32 s98, 0
    s_waitcnt vmcnt(0)
    s_mov_b64 exec, s[4:5]
    s_cbranch_execz L_h2s0
    v_pk_add_f32 v[20:21], v[176:177], v[178:179]
    v_pk_add_f32 v[22:23], v[180:181], v[182:183]
    v_cmp_u_f32 s[20:21], v20, v21
    v_cmp_u_f32 s[22:23], v22, v23
    v_pk_add_f32 v[64:65], v[176:177], v[180:181]
    v_pk_add_f32 v[66:67], v[178:179], v[182:183]
    s_or_b64 s[4:5], s[20:21], s[22:23]
    s_cbranch_scc0 L_h2s0
    s_mov_b64 exec, s[20:21]
    buffer_load_dwordx4 v[176:179], v40, s[32:35], s48 offen offset:0 sc1
    s_mov_b64 exec, s[22:23]
    buffer_load_dwordx4 v[180:183], v40, s[32:35], s48 offen offset:3584 sc1
    s_add_u32 s98, s98, 1
L_h2s0:
    s_mov_b64 exec, s[6:7]
    s_cbranch_execz L_h2s1
    v_pk_add_f32 v[20:21], v[184:185], v[186:187]
    v_pk_add_f32 v[22:23], v[188:189], v[190:191]
    v_cmp_u_f32 s[20:21], v20, v21
    v_cmp_u_f32 s[22:23], v22, v23
    v_pk_add_f32 v[68:69], v[184:185], v[188:189]
    v_pk_add_f32 v[70:71], v[186:187], v[190:191]
    s_or_b64 s[6:7], s[20:21], s[22:23]
    s_cbranch_scc0 L_h2s1
    s_mov_b64 exec, s[20:21]
    buffer_load_dwordx4 v[184:187], v41, s[32:35], s48 offen offset:0 sc1
    s_mov_b64 exec, s[22:23]
    buffer_load_dwordx4 v[188:191], v41, s[32:35], s48 offen offset:3584 sc1
    s_add_u32 s98, s98, 1
L_h2s1:
    s_mov_b64 exec, s[8:9]
    s_cbranch_execz L_h2s2
    v_pk_add_f32 v[20:21], v[192:193], v[194:195]
    v_pk_add_f32 v[22:23], v[196:197], v[198:199]
    v_cmp_u_f32 s[20:21], v20, v21
    v_cmp_u_f32 s[22:23], v22, v23
    v_pk_add_f32 v[72:73], v[192:193], v[196:197]
    v_pk_add_f32 v[74:75], v[194:195], v[198:199]
    s_or_b64 s[8:9], s[20:21], s[22:23]
    s_cbranch_scc0 L_h2s2
    s_mov_b64 exec, s[20:21]
    buffer_load_dwordx4 v[192:195], v42, s[32:35], s48 offen offset:0 sc1
    s_mov_b64 exec, s[22:23]
    buffer_load_dwordx4 v[196:199], v42, s[32:35], s48 offen offset:3584 sc1
    s_add_u32 s98, s98, 1
L_h2s2:
    s_mov_b64 exec, s[10:11]
    s_cbranch_execz L_h2s3
    v_pk_add_f32 v[20:21], v[200:201], v[202:203]
    v_pk_add_f32 v[22:23], v[204:205], v[206:207]
    v_cmp_u_f32 s[20:21], v20, v21
    v_cmp_u_f32 s[22:23], v22, v23
    v_pk_add_f32 v[76:77], v[200:201], v[204:205]
    v_pk_add_f32 v[78:79], v[202:203], v[206:207]
    s_or_b64 s[10:11], s[20:21], s[22:23]
    s_cbranch_scc0 L_h2s3
    s_mov_b64 exec, s[20:21]
    buffer_load_dwordx4 v[200:203], v43, s[32:35], s48 offen offset:0 sc1
    s_mov_b64 exec, s[22:23]
    buffer_load_dwordx4 v[204:207], v43, s[32:35], s48 offen offset:3584 sc1
    s_add_u32 s98, s98, 1
L_h2s3:
    s_mov_b64 exec, s[12:13]
    s_cbranch_execz L_h2s4
    v_pk_add_f32 v[20:21], v[208:209], v[210:211]
    v_pk_add_f32 v[22:23], v[212:213], v[214:215]
    v_cmp_u_f32 s[20:21], v20, v21
    v_cmp_u_f32 s[22:23], v22, v23
    v_pk_add_f32 v[80:81], v[208:209], v[212:213]
    v_pk_add_f32 v[82:83], v[210:211], v[214:215]
    s_or_b64 s[12:13], s[20:21], s[22:23]
    s_cbranch_scc0 L_h2s4
    s_mov_b64 exec, s[20:21]
    buffer_load_dwordx4 v[208:211], v44, s[32:35], s48 offen offset:0 sc1
    s_mov_b64 exec, s[22:23]
    buffer_load_dwordx4 v[212:215], v44, s[32:35], s48 offen offset:3584 sc1
    s_add_u32 s98, s98, 1
L_h2s4:
    s_mov_b64 exec, s[14:15]
    s_cbranch_execz L_h2s5
    v_pk_add_f32 v[20:21], v[216:217], v[218:219]
    v_pk_add_f32 v[22:23], v[220:221], v[222:223]
    v_cmp_u_f32 s[20:21], v20, v21
    v_cmp_u_f32 s[22:23], v22, v23
    v_pk_add_f32 v[84:85], v[216:217], v[220:221]
    v_pk_add_f32 v[86:87], v[218:219], v[222:223]
    s_or_b64 s[14:15], s[20:21], s[22:23]
    s_cbranch_scc0 L_h2s5
    s_mov_b64 exec, s[20:21]
    buffer_load_dwordx4 v[216:219], v45, s[32:35], s48 offen offset:0 sc1
    s_mov_b64 exec, s[22:23]
    buffer_load_dwordx4 v[220:223], v45, s[32:35], s48 offen offset:3584 sc1
    s_add_u32 s98, s98, 1
L_h2s5:
    s_mov_b64 exec, s[16:17]
    s_cbranch_execz L_h2s6
    v_pk_add_f32 v[20:21], v[224:225], v[226:227]
    v_pk_add_f32 v[22:23], v[228:229], v[230:231]
    v_cmp_u_f32 s[20:21], v20, v21
    v_cmp_u_f32 s[22:23], v22, v23
    v_pk_add_f32 v[88:89], v[224:225], v[228:229]
    v_pk_add_f32 v[90:91], v[226:227], v[230:231]
    s_or_b64 s[16:17], s[20:21], s[22:23]
    s_cbranch_scc0 L_h2s6
    s_mov_b64 exec, s[20:21]
    buffer_load_dwordx4 v[224:227], v46, s[32:35], s48 offen offset:0 sc1
    s_mov_b64 exec, s[22:23]
    buffer_load_dwordx4 v[228:231], v46, s[32:35], s48 offen offset:3584 sc1
    s_add_u32 s98, s98, 1
    s_branch L_over10
.fill 10, 4, 0xbf810000
P_10:
    s_branch P_12
L_over10:
L_h2s6:
    s_mov_b64 exec, s[18:19]
    s_cbranch_execz L_h2s7
    v_pk_add_f32 v[20:21], v[232:233], v[234:235]
    v_pk_add_f32 v[22:23], v[236:237], v[238:239]
    v_cmp_u_f32 s[20:21], v20, v21
    v_cmp_u_f32 s[22:23], v22, v23
    v_pk_add_f32 v[92:93], v[232:233], v[236:237]
    v_pk_add_f32 v[94:95], v[234:235], v[238:239]
    s_or_b64 s[18:19], s[20:21], s[22:23]
    s_cbranch_scc0 L_h2s7
    s_mov_b64 exec, s[20:21]
    buffer_load_dwordx4 v[232:235], v47, s[32:35], s48 offen offset:0 sc1
    s_mov_b64 exec, s[22:23]
    buffer_load_dwordx4 v[236:239], v47, s[32:35], s48 offen offset:3584 sc1
    s_add_u32 s98, s98, 1
L_h2s7:
    s_mov_b64 exec, -1
    s_sub_u32 s29, s29, 1
    s_cselect_b32 s98, 0, s98
    s_cmp_lg_u32 s98, 0
    s_cbranch_scc1 L_h2
    v_pk_add_f32 v[64:65], v[64:65], v[68:69]
    v_pk_add_f32 v[66:67], v[66:67], v[70:71]
    v_pk_add_f32 v[72:73], v[72:73], v[76:77]
    v_pk_add_f32 v[74:75], v[74:75], v[78:79]
    v_pk_add_f32 v[80:81], v[80:81], v[84:85]
    v_pk_add_f32 v[82:83], v[82:83], v[86:87]
    v_pk_add_f32 v[88:89], v[88:89], v[92:93]
    v_pk_add_f32 v[90:91], v[90:91], v[94:95]
    v_pk_add_f32 v[64:65], v[64:65], v[72:73]
    v_pk_add_f32 v[66:67], v[66:67], v[74:75]
    v_pk_add_f32 v[80:81], v[80:81], v[88:89]
    v_pk_add_f32 v[82:83], v[82:83], v[90:91]
    v_pk_add_f32 v[16:17], v[64:65], v[80:81]
    v_pk_add_f32 v[18:19], v[66:67], v[82:83]
    v_cvt_pk_bf16_f32 v6, v16, v17
    v_cvt_pk_bf16_f32 v7, v18, v19
    v_lshlrev_b32 v16, 16, v6
    v_and_b32 v17, 0xffff0000, v6
    v_lshlrev_b32 v18, 16, v7
    v_and_b32 v19, 0xffff0000, v7
    v_pk_add_f32 v[52:53], v[16:17], v[52:53]
    v_pk_add_f32 v[54:55], v[18:19], v[54:55]
    v_cvt_pk_bf16_f32 v6, v52, v53
    v_cvt_pk_bf16_f32 v7, v54, v55
    v_lshlrev_b32 v52, 16, v6
    v_and_b32 v53, 0xffff0000, v6
    v_lshlrev_b32 v54, 16, v7
    v_and_b32 v55, 0xffff0000, v7
    v_pk_add_f32 v[34:35], v[52:53], v[54:55]
    v_pk_mul_f32 v[36:37], v[52:53], v[52:53]
    v_pk_fma_f32 v[36:37], v[54:55], v[54:55], v[36:37]
    v_add_f32 v32, v34, v35
    v_add_f32 v33, v36, v37
    s_nop 0
    v_add_f32_dpp v32, v32, v32 quad_perm:[1,0,3,2] row_mask:0xf bank_mask:0xf
    v_add_f32_dpp v33, v33, v33 quad_perm:[1,0,3,2] row_mask:0xf bank_mask:0xf
    s_nop 0
    v_add_f32_dpp v32, v32, v32 quad_perm:[2,3,0,1] row_mask:0xf bank_mask:0xf
    v_add_f32_dpp v33, v33, v33 quad_perm:[2,3,0,1] row_mask:0xf bank_mask:0xf
    s_nop 0
    v_add_f32_dpp v32, v32, v32 row_half_mirror row_mask:0xf bank_mask:0xf
    v_add_f32_dpp v33, v33, v33 row_half_mirror row_mask:0xf bank_mask:0xf
    s_nop 0
    v_add_f32_dpp v32, v32, v32 row_mirror row_mask:0xf bank_mask:0xf
    v_add_f32_dpp v33, v33, v33 row_mirror row_mask:0xf bank_mask:0xf
    v_mov_b32 v34, v32
    v_mov_b32 v35, v33
    s_nop 0
    v_permlane16_swap_b32 v32, v34
    v_permlane16_swap_b32 v33, v35
    v_add_f32 v32, v32, v34
    v_add_f32 v33, v33, v35
    s_mov_b32 exec_lo, 1
    s_mov_b32 exec_hi, 1
    ds_write_b64 v25, v[32:33]
    s_mov_b64 exec, -1
    s_waitcnt lgkmcnt(0)
    s_barrier
    ds_read_b128 v[36:39], v24
    ds_read_b128 v[56:59], v24 offset:16
    s_waitcnt lgkmcnt(0)
    v_pk_add_f32 v[36:37], v[36:37], v[38:39]
    v_pk_add_f32 v[56:57], v[56:57], v[58:59]
    v_pk_add_f32 v[36:37], v[36:37], v[56:57]
    v_mul_f32 v36, s54, v36
    v_mul_f32 v38, s54, v37
    v_fma_f32 v38, -v36, v36, v38
    v_max_f32 v38, 0, v38
    v_cvt_pk_bf16_f32 v6, v36, v38
    v_and_b32 v38, 0xffff0000, v6
    v_lshlrev_b32 v36, 16, v6
    v_lshlrev_b32 v37, 16, v6
    v_add_f32 v38, 0x3727c5ac, v38
    v_pk_add_f32 v[16:17], v[52:53], v[36:37] neg_lo:[0,1] neg_hi:[0,1]
    v_cvt_pk_bf16_f32 v38, v38, v38
    v_and_b32 v38, 0xffff0000, v38
    v_sqrt_f32 v38, v38
    v_pk_add_f32 v[18:19], v[54:55], v[36:37] neg_lo:[0,1] neg_hi:[0,1]
    v_cvt_pk_bf16_f32 v38, v38, v38
    v_and_b32 v38, 0xffff0000, v38
    v_rcp_f32 v38, v38
    v_cvt_pk_bf16_f32 v6, v16, v17
    v_cvt_pk_bf16_f32 v7, v18, v19
    v_lshlrev_b32 v16, 16, v6
    v_and_b32 v17, 0xffff0000, v6
    v_lshlrev_b32 v18, 16, v7
    v_and_b32 v19, 0xffff0000, v7
    v_pk_mul_f32 v[16:17], v[16:17], v[38:39] op_sel_hi:[1,0]
    v_pk_mul_f32 v[18:19], v[18:19], v[38:39] op_sel_hi:[1,0]
    v_cvt_pk_bf16_f32 v20, v16, v17
    v_cvt_pk_bf16_f32 v21, v18, v19
    ds_write_b64 v26, v[20:21]
    ds_read_b128 v[64:67], v27 offset:0
    ds_read_b128 v[68:71], v27 offset:64
    ds_read_b128 v[72:75], v27 offset:128
    ds_read_b128 v[76:79], v27 offset:192
    s_mov_b32 s54, 0xbdd2d3e8
    v_mov_b32 v6, 0xc0135761
    s_mov_b32 s4, 0x00110011
    s_mov_b32 s5, s4
    s_mov_b32 s6, 0x00220022
    s_mov_b32 s7, s6
    s_mov_b32 s8, 0x00440044
    s_mov_b32 s9, s8
    s_mov_b32 s10, 0x00880088
    s_mov_b32 s11, s10
    s_mov_b32 s12, 0x11001100
    s_mov_b32 s13, s12
    s_mov_b32 s14, 0x22002200
    s_mov_b32 s15, s14
    s_mov_b32 s16, 0x44004400
    s_mov_b32 s17, s16
    s_waitcnt lgkmcnt(3)
    v_mfma_f32_16x16x32_bf16 v[32:35], v[128:131], v[64:67], 0
    v_mfma_f32_16x16x32_bf16 v[36:39], v[144:147], v[64:67], 0
    s_waitcnt lgkmcnt(2)
    v_mfma_f32_16x16x32_bf16 v[32:35], v[132:135], v[68:71], v[32:35]
    v_mfma_f32_16x16x32_bf16 v[36:39], v[148:151], v[68:71], v[36:39]
    s_waitcnt lgkmcnt(1)
    v_mfma_f32_16x16x32_bf16 v[32:35], v[136:139], v[72:75], v[32:35]
    v_mfma_f32_16x16x32_bf16 v[36:39], v[152:155], v[72:75], v[36:39]
    s_waitcnt lgkmcnt(0)
    v_mfma_f32_16x16x32_bf16 v[32:35], v[140:143], v[76:79], v[32:35]
    v_mfma_f32_16x16x32_bf16 v[36:39], v[156:159], v[76:79], v[36:39]
    s_branch L_over11
.fill 37, 4, 0xbf810000
P_11:
    s_branch L_w4b
L_over11:
    s_mov_b32 exec_lo, 0x00110011
    s_mov_b32 exec_hi, 0x00110011
    s_nop 3
    ds_write_b128 v29, v[32:35]
    ds_write_b128 v29, v[36:39] offset:128
    s_mov_b64 exec, -1
    s_waitcnt lgkmcnt(0)
    s_barrier
    ds_read2_b32 v[64:65], v31 offset0:0 offset1:64
    ds_read2_b32 v[66:67], v31 offset0:128 offset1:192
    ds_read2_b32 v[68:69], v31 offset0:32 offset1:96
    ds_read2_b32 v[70:71], v31 offset0:160 offset1:224
    s_waitcnt lgkmcnt(2)
    v_pk_add_f32 v[64:65], v[64:65], v[66:67]
    v_add_f32 v64, v64, v65
    v_cvt_pk_bf16_f32 v64, v64, v64
    v_and_b32 v64, 0xffff0000, v64
    v_mul_f32 v65, v64, v64
    v_fma_f32 v65, v65, s54, v6
    v_mul_f32 v65, v65, v64
    v_exp_f32 v65, v65
    s_waitcnt lgkmcnt(0)
    v_pk_add_f32 v[68:69], v[68:69], v[70:71]
    v_add_f32 v65, 1.0, v65
    v_rcp_f32 v65, v65
    v_add_f32 v68, v68, v69
    v_mul_f32 v64, v64, v65
    v_cvt_pk_bf16_f32 v7, v64, v68
    v_lshlrev_b32 v64, 16, v7
    v_and_b32 v68, 0xffff0000, v7
    v_mul_f32 v64, v64, v68
    s_nop 1
    v_mov_b32_dpp v72, v64 quad_perm:[0,0,0,0] row_mask:0xf bank_mask:0xf
    v_mov_b32_dpp v73, v64 quad_perm:[1,1,1,1] row_mask:0xf bank_mask:0xf
    v_mov_b32_dpp v74, v64 quad_perm:[2,2,2,2] row_mask:0xf bank_mask:0xf
    v_mov_b32_dpp v75, v64 quad_perm:[3,3,3,3] row_mask:0xf bank_mask:0xf
    v_cvt_pk_bf16_f32 v20, v72, v73
    v_cvt_pk_bf16_f32 v21, v74, v75
    v_cndmask_b32 v96, 0, v20, s[4:5]
    v_cndmask_b32 v97, 0, v21, s[4:5]
    v_cndmask_b32 v98, 0, v20, s[6:7]
    v_cndmask_b32 v99, 0, v21, s[6:7]
    v_mfma_f32_16x16x16_bf16 v[32:35], v[160:161], v[96:97], 0
    v_cndmask_b32 v100, 0, v20, s[8:9]
    v_cndmask_b32 v101, 0, v21, s[8:9]
    v_mfma_f32_16x16x16_bf16 v[32:35], v[162:163], v[98:99], v[32:35]
    v_cndmask_b32 v102, 0, v20, s[10:11]
    v_cndmask_b32 v103, 0, v21, s[10:11]
    v_mfma_f32_16x16x16_bf16 v[32:35], v[164:165], v[100:101], v[32:35]
    v_cndmask_b32 v104, 0, v20, s[12:13]
    v_cndmask_b32 v105, 0, v21, s[12:13]
    v_mfma_f32_16x16x16_bf16 v[32:35], v[166:167], v[102:103], v[32:35]
    v_cndmask_b32 v106, 0, v20, s[14:15]
    v_cndmask_b32 v107, 0, v21, s[14:15]
    v_mfma_f32_16x16x16_bf16 v[32:35], v[168:169], v[104:105], v[32:35]
    v_cndmask_b32 v108, 0, v20, s[16:17]
    v_cndmask_b32 v109, 0, v21, s[16:17]
    v_mfma_f32_16x16x16_bf16 v[32:35], v[170:171], v[106:107], v[32:35]
    s_nop 0
    v_mfma_f32_16x16x16_bf16 v[32:35], v[172:173], v[108:109], v[32:35]
    s_lshr_b32 s50, s2, 3
    s_lshl_b32 s50, s50, 2
    s_and_b32 s51, s2, 3
    s_add_u32 s50, s50, s51
    s_lshr_b32 s51, s50, 1
    s_mul_i32 s52, s30, 7
    s_sub_u32 s52, s51, s52
    s_and_b32 s53, s50, 1
    s_mov_b32 exec_lo, 0x77ff77ff
    s_mov_b32 exec_hi, 0x77ff77ff
    buffer_store_dwordx4 v[32:35], v30, s[32:35], s49 offen sc1
    s_mov_b64 exec, -1
    s_cmp_ge_u32 s52, 7
    s_cbranch_scc1 L_fin
    s_mul_i32 s4, s51, 14336
    s_lshl_b32 s5, s53, 6
    s_add_u32 s4, s4, s5
    s_add_u32 s4, s4, 647168
    s_add_u32 s5, s4, 4096
    s_add_u32 s6, s4, 8192
    s_add_u32 s7, s4, 12288
    s_lshl_b32 s52, s52, 2
    s_lshl_b32 s53, s53, 5
    s_add_u32 s52, s52, s53
    s_lshl_b64 s[8:9], 15, s52
    s_waitcnt vmcnt(0)
    s_mov_b32 s29, 131072
    s_mov_b64 s[10:11], -1
    s_mov_b64 s[12:13], -1
    s_mov_b64 s[14:15], -1
    s_mov_b64 s[16:17], -1
    s_mov_b64 s[18:19], -1
    s_mov_b64 s[20:21], -1
    s_mov_b64 s[22:23], -1
L_h3:
    s_or_b64 exec, s[10:11], 1
    buffer_load_dwordx4 v[64:67], v13, s[32:35], s4 offen offset:0 sc1
    s_or_b64 exec, s[12:13], 1
    buffer_load_dwordx4 v[68:71], v13, s[32:35], s4 offen offset:2048 sc1
    s_or_b64 exec, s[14:15], 1
    buffer_load_dwordx4 v[72:75], v13, s[32:35], s5 offen offset:0 sc1
    s_or_b64 exec, s[16:17], 1
    buffer_load_dwordx4 v[76:79], v13, s[32:35], s5 offen offset:2048 sc1
    s_or_b64 exec, s[18:19], 1
    buffer_load_dwordx4 v[80:83], v13, s[32:35], s6 offen offset:0 sc1
    s_or_b64 exec, s[20:21], 1
    buffer_load_dwordx4 v[84:87], v13, s[32:35], s6 offen offset:2048 sc1
    s_or_b64 exec, s[22:23], 1
    buffer_load_dwordx4 v[88:91], v13, s[32:35], s7 offen offset:0 sc1
    s_mov_b64 exec, -1
    s_waitcnt vmcnt(5)
    v_pk_add_f32 v[16:17], v[64:65], v[68:69]
    v_pk_add_f32 v[18:19], v[66:67], v[70:71]
    s_waitcnt vmcnt(3)
    v_pk_add_f32 v[20:21], v[72:73], v[76:77]
    v_pk_add_f32 v[22:23], v[74:75], v[78:79]
    s_waitcnt vmcnt(2)
    v_pk_add_f32 v[16:17], v[16:17], v[80:81]
    v_pk_add_f32 v[18:19], v[18:19], v[82:83]
    s_waitcnt vmcnt(1)
    v_pk_add_f32 v[20:21], v[20:21], v[84:85]
    v_pk_add_f32 v[22:23], v[22:23], v[86:87]
    s_waitcnt vmcnt(0)
    v_pk_add_f32 v[16:17], v[16:17], v[88:89]
    v_pk_add_f32 v[18:19], v[18:19], v[90:91]
    v_pk_add_f32 v[16:17], v[16:17], v[20:21]
    v_pk_add_f32 v[18:19], v[18:19], v[22:23]
    v_pk_add_f32 v[20:21], v[16:17], v[18:19]
    v_cmp_u_f32 vcc, v20, v21
    s_nop 0
    s_cbranch_vccz L_h3ok
    s_branch L_over12
.fill 69, 4, 0xbf810000
P_12:
    s_branch L_w3b
L_over12:
    v_pk_add_f32 v[20:21], v[64:65], v[66:67]
    v_cmp_u_f32 s[10:11], v20, v21
    v_pk_add_f32 v[22:23], v[68:69], v[70:71]
    v_cmp_u_f32 s[12:13], v22, v23
    v_pk_add_f32 v[20:21], v[72:73], v[74:75]
    v_cmp_u_f32 s[14:15], v20, v21
    v_pk_add_f32 v[22:23], v[76:77], v[78:79]
    v_cmp_u_f32 s[16:17], v22, v23
    v_pk_add_f32 v[20:21], v[80:81], v[82:83]
    v_cmp_u_f32 s[18:19], v20, v21
    v_pk_add_f32 v[22:23], v[84:85], v[86:87]
    v_cmp_u_f32 s[20:21], v22, v23
    v_pk_add_f32 v[20:21], v[88:89], v[90:91]
    v_cmp_u_f32 s[22:23], v20, v21
    s_sub_u32 s29, s29, 1
    s_cbranch_scc0 L_h3
L_h3ok:
    v_add_f32_dpp v16, v16, v16 row_ror:4 row_mask:0xf bank_mask:0xf
    v_add_f32_dpp v17, v17, v17 row_ror:4 row_mask:0xf bank_mask:0xf
    v_add_f32_dpp v18, v18, v18 row_ror:4 row_mask:0xf bank_mask:0xf
    v_add_f32_dpp v19, v19, v19 row_ror:4 row_mask:0xf bank_mask:0xf
    v_add_f32_dpp v16, v16, v16 row_ror:8 row_mask:0xf bank_mask:0xf
    v_add_f32_dpp v17, v17, v17 row_ror:8 row_mask:0xf bank_mask:0xf
    v_add_f32_dpp v18, v18, v18 row_ror:8 row_mask:0xf bank_mask:0xf
    v_add_f32_dpp v19, v19, v19 row_ror:8 row_mask:0xf bank_mask:0xf
    v_mov_b32 v20, v16
    v_mov_b32 v21, v17
    v_mov_b32 v22, v18
    v_mov_b32 v23, v19
    v_permlane16_swap_b32 v16, v20
    v_permlane16_swap_b32 v17, v21
    v_permlane16_swap_b32 v18, v22
    v_permlane16_swap_b32 v19, v23
    v_add_f32 v16, v16, v20
    v_add_f32 v17, v17, v21
    v_add_f32 v18, v18, v22
    v_add_f32 v19, v19, v23
    v_mov_b32 v20, v16
    v_mov_b32 v21, v17
    v_mov_b32 v22, v18
    v_mov_b32 v23, v19
    v_permlane32_swap_b32 v16, v20
    v_permlane32_swap_b32 v17, v21
    v_permlane32_swap_b32 v18, v22
    v_permlane32_swap_b32 v19, v23
    v_add_f32 v16, v16, v20
    v_add_f32 v17, v17, v21
    v_add_f32 v18, v18, v22
    v_add_f32 v19, v19, v23
    v_cvt_pk_bf16_f32 v6, v16, v17
    v_cvt_pk_bf16_f32 v7, v18, v19
    v_lshlrev_b32 v16, 16, v6
    v_and_b32 v17, 0xffff0000, v6
    v_lshlrev_b32 v18, 16, v7
    v_and_b32 v19, 0xffff0000, v7
    v_pk_add_f32 v[16:17], v[16:17], v[52:53]
    v_pk_add_f32 v[18:19], v[18:19], v[54:55]
    v_cvt_pk_bf16_f32 v20, v16, v17
    v_cvt_pk_bf16_f32 v21, v18, v19
    s_mov_b64 exec, s[8:9]
    buffer_store_dwordx2 v[20:21], v10, s[44:47], 0 offen sc0 sc1
    s_cmp_lg_u32 s50, 0
    s_cbranch_scc1 L_fin
    s_mov_b64 exec, 1
    v_mov_b32 v8, s28
    v_mov_b32 v4, 0
    buffer_store_dword v8, v4, s[32:35], 0 offen sc1
    s_branch L_fin
L_idle:
    s_barrier
L_fin:
L_end:
    s_endpgm
.section .rodata,"a"
.p2align 6
.amdhsa_kernel sequential_preLN__mha_block_cached__geglu_ffn__decode_kernel
  .amdhsa_next_free_vgpr 240
  .amdhsa_next_free_sgpr 102
  .amdhsa_accum_offset 240
  .amdhsa_group_segment_fixed_size 0
  .amdhsa_kernarg_size 96
  .amdhsa_user_sgpr_count 2
  .amdhsa_user_sgpr_kernarg_segment_ptr 1
  .amdhsa_system_sgpr_workgroup_id_x 1
  .amdhsa_float_denorm_mode_32 3
.end_amdhsa_kernel
```
